```python
import torch

def _softmax(x, axis=-1):
    return torch.softmax(x, dim=axis)
def _gelu(x):
    return torch.nn.functional.gelu(x, approximate="tanh")
def _silu(x):
    return torch.nn.functional.silu(x)
def _sigmoid(x):
    return torch.sigmoid(x)
def _layernorm(x, axis=-1, eps=1e-5):
    m = x.mean(dim=axis, keepdim=True)
    v = x.var(dim=axis, keepdim=True, unbiased=False)
    return (x - m) / torch.sqrt(v + eps)
def _scatter_add(tgt, idx, src, axis=0):
    return tgt.clone().index_add_(axis, idx, src)
def _segment_sum(src, seg, n):
    out = torch.zeros((n,) + src.shape[1:], dtype=src.dtype)
    return out.index_add_(0, seg, src)
def _pad(x, pw):
    flat = tuple(v for pair in reversed(pw) for v in pair)
    return torch.nn.functional.pad(x, flat)

kernel_name = 'standalone__attention_interact_autoint__recsys'

def setup_inputs():

    _w = (lambda a: (lambda t: t.to(torch.bfloat16) if t.is_floating_point() else t)(torch.as_tensor(a)))
    B, F = 1024, 100
    D = max(2, (64 // 2) * 2)
    H = 2
    Dh = D // H
    return {
        "e": _w((lambda *s: torch.randn(*s, dtype=torch.bfloat16) * 0.05)(B, F, D).to(float)),
        "wq": _w((lambda *s: torch.randn(*s, dtype=torch.bfloat16) * 3.2)(H, D, Dh).to(float)),
        "wk": _w((lambda *s: torch.randn(*s, dtype=torch.bfloat16) * 3.2)(H, D, Dh).to(float)),
        "wv": _w((lambda *s: torch.randn(*s, dtype=torch.bfloat16) * 0.05)(H, D, Dh).to(float)),
        "wres": _w((lambda *s: torch.randn(*s, dtype=torch.bfloat16) * 0.05)(D, D).to(float)),
    }

def reference(e, wq, wk, wv, wres):
    H, D, Dh = wq.shape[0], wq.shape[1], wq.shape[2]
    B, F = e.shape[0], e.shape[1]
    q = torch.einsum('bfd,hdk->bhfk', e, wq)
    k = torch.einsum('bfd,hdk->bhfk', e, wk)
    v = torch.einsum('bfd,hdk->bhfk', e, wv)
    scale = float(Dh) ** -0.5
    scores = torch.einsum('bhfk,bhgk->bhfg', q, k) * scale
    attn = _softmax(scores, axis=-1)
    attn = (lambda x, dt: x.to(dt))(attn, v.dtype)
    ctx = torch.einsum('bhfg,bhgk->bhfk', attn, v)
    ctx = (lambda x, *d: x.permute(*d))(ctx, 0, 2, 1, 3).reshape(B, F, H * Dh)
    res = torch.einsum('bfd,de->bfe', e, wres)
    out = ctx + res
    mask = (lambda x, dt: x.to(dt))(out > 0, out.dtype)
    return out * mask
```

```asm
; @launch grid=(256,1,1) block=(256,1,1) lds=113280
.amdgcn_target "amdgcn-amd-amdhsa--gfx950"
.text
.globl standalone__attention_interact_autoint__recsys_kernel
.p2align 12
.rept 448
    s_endpgm
.endr
.p2align 8
.type standalone__attention_interact_autoint__recsys_kernel,@function
standalone__attention_interact_autoint__recsys_kernel:
    s_load_dwordx8 s[4:11], s[0:1], 0
    s_load_dwordx4 s[12:15], s[0:1], 32
    s_getpc_b64 s[48:49]
    s_lshr_b32 s50, s2, 5
    v_and_b32 v34, -8, v0
    s_cmpk_ge_u32 s2, 0x100
    v_add_lshl_u32 v34, v34, s50, 6
    s_cbranch_scc1 L_end
    global_load_dword v48, v34, s[48:49]
    v_lshrrev_b32 v33, 6, v0
    v_and_b32 v32, 63, v0
    v_readfirstlane_b32 s28, v33
    v_lshrrev_b32 v33, 3, v32
    v_lshlrev_b32 v33, 7, v33
    v_lshrrev_b32 v34, 4, v32
    v_and_b32 v35, 7, v32
    v_xor_b32 v34, v34, v35
    v_lshl_add_u32 v38, v34, 4, v33
    v_xor_b32 v39, 64, v38
    v_lshlrev_b32 v40, 4, v32
    v_lshrrev_b32 v34, 2, v32
    v_lshlrev_b32 v34, 7, v34
    v_and_b32 v35, 3, v32
    v_lshl_add_u32 v41, v35, 4, v34
    s_lshl_b32 s29, s2, 2
    s_add_u32 s29, s29, s28
    s_mul_i32 s43, s29, 12800
    s_mul_i32 s31, s28, 17952
    s_add_u32 s31, s31, 32768
    s_lshl_b32 s33, s28, 11
    s_and_b32 s34, s28, 1
    s_lshl_b32 s34, s34, 12
    s_lshr_b32 s42, s28, 1
    s_lshl_b32 s42, s42, 6
    s_add_u32 s34, s34, s42
    s_add_u32 s35, s34, 0x400
    s_movk_i32 s38, 0x1000
    s_movk_i32 s39, 0x2000
    s_movk_i32 s40, 0x3000
    s_movk_i32 s18, 12800
    s_mov_b32 s19, 0x20000
    s_movk_i32 s22, 0x2000
    s_mov_b32 s23, 0x20000
    v_and_b32 v33, 31, v32
    v_lshrrev_b32 v34, 5, v32
    v_bfe_u32 v35, v32, 2, 2
    v_lshl_add_u32 v35, v34, 3, v35
    v_lshlrev_b32 v35, 6, v35
    v_bfe_u32 v36, v32, 4, 1
    v_lshl_add_u32 v35, v36, 5, v35
    v_and_b32 v36, 1, v32
    v_lshl_add_u32 v35, v36, 4, v35
    v_bfe_u32 v36, v32, 1, 1
    v_lshl_add_u32 v16, v36, 3, v35
    v_bfe_u32 v35, v32, 1, 3
    v_xor_b32 v35, v35, v34
    v_lshlrev_b32 v35, 4, v35
    v_lshl_add_u32 v35, v33, 7, v35
    v_add_u32 v6, s31, v35
    v_xad_u32 v7, v35, 32, s31
    v_xad_u32 v8, v35, 64, s31
    v_xor_b32_e64 v36, 32, v35
    v_xad_u32 v9, v36, 64, s31
    s_movk_i32 s26, 12800
    s_mov_b32 s27, 0x20000
    s_mov_b32 s66, 0x0f0f0f0f
    s_mov_b32 s67, 0x0f0f0f0f
    s_mov_b32 s68, 0x000f
    s_mov_b32 s69, 0x0f00
    s_mov_b32 s70, 0xff00ff00
    s_mov_b32 s71, 0xff00ff00
    v_and_b32 v33, 19, v32
    v_bfe_u32 v34, v32, 2, 1
    v_lshl_add_u32 v33, v34, 3, v33
    v_bfe_u32 v34, v32, 3, 1
    v_lshl_add_u32 v33, v34, 2, v33
    v_lshrrev_b32 v34, 5, v32
    v_bfe_u32 v35, v33, 1, 3
    v_xor_b32 v35, v35, v34
    v_lshlrev_b32 v35, 4, v35
    v_lshl_add_u32 v35, v33, 7, v35
    v_add_u32 v24, s31, v35
    v_xad_u32 v25, v35, 32, s31
    v_xad_u32 v26, v35, 64, s31
    v_xor_b32 v36, 32, v35
    v_xad_u32 v27, v36, 64, s31
    v_mov_b32 v21, 0xdddd
    v_mov_b32 v35, 0x3f803f80
    s_mov_b32 vcc_lo, 0x1010101
    s_mov_b32 vcc_hi, 0x1010101
    v_cndmask_b32 v33, 0, v35, vcc
    s_mov_b32 vcc_lo, 0x10101010
    s_mov_b32 vcc_hi, 0x10101010
    v_cndmask_b32 v34, 0, v35, vcc
    v_accvgpr_write_b32 a0, v33
    v_accvgpr_write_b32 a1, v33
    v_accvgpr_write_b32 a2, v34
    v_accvgpr_write_b32 a3, v34
    v_accvgpr_write_b32 a12, 0
    v_accvgpr_write_b32 a13, 0
    v_accvgpr_write_b32 a14, 0
    v_accvgpr_write_b32 a15, 0
    v_lshrrev_b32 v34, 5, v32
    v_and_b32 v33, 3, v32
    v_bfe_u32 v35, v32, 1, 1
    v_lshrrev_b32 v47, 4, v32
    v_xor_b32_e64 v35, v35, v47
    s_waitcnt lgkmcnt(0)
    s_add_u32 s16, s4, s43
    s_addc_u32 s17, s5, 0
    s_mov_b64 s[20:21], s[6:7]
    buffer_load_dwordx4 v[48:51], v40, s[20:23], s33 offen
    buffer_load_dwordx4 v[52:55], v40, s[20:23], s33 offen offset:1024
    s_add_u32 m0, s33, 0x2000
    s_mov_b64 s[20:21], s[8:9]
    buffer_load_dwordx4 v40, s[20:23], s33 offen lds
    buffer_load_dwordx4 v40, s[20:23], s33 offen offset:1024 lds
    s_add_u32 m0, s31, 12288
    s_nop 0
    buffer_load_dwordx4 v38, s[16:19], s40 offen nt lds
    s_mov_b32 m0, s31
    s_nop 0
    buffer_load_dwordx4 v38, s[16:19], 0 offen nt lds
    buffer_load_dwordx4 v39, s[16:19], 0 offen offset:1024 nt lds
    buffer_load_dwordx4 v38, s[16:19], 0 offen offset:2048 nt lds
    buffer_load_dwordx4 v39, s[16:19], 0 offen offset:3072 nt lds
    s_add_u32 m0, s33, 0x4000
    s_mov_b64 s[20:21], s[10:11]
    buffer_load_dwordx4 v40, s[20:23], s33 offen lds
    buffer_load_dwordx4 v40, s[20:23], s33 offen offset:1024 lds
    s_add_u32 s24, s14, s43
    s_addc_u32 s25, s15, 0
    v_mfma_f32_32x32x16_bf16 v[80:95], a[12:15], a[12:15], 0
    v_accvgpr_write_b32 a28, 0
    v_lshlrev_b32_e64 v35, 4, v35
    v_lshl_add_u32 v35, v33, 7, v35
    v_bfe_u32 v36, v32, 2, 2
    v_lshl_add_u32 v46, v47, 3, v36
    v_lshlrev_b32_e64 v46, 6, v46
    v_lshl_add_u32 v46, v33, 4, v46
    v_mfma_f32_32x32x16_bf16 v[96:111], a[12:15], a[12:15], 0
    v_accvgpr_write_b32 a32, 0
    v_mul_u32_u24 v36, 0x4620, v36
    v_add_u32 v36, 0xb000, v36
    v_add_u32 v44, v35, v36
    v_xad_u32 v45, v35, 64, v36
    s_mul_i32 s45, s28, 1088
    s_add_u32 s45, s45, 104576
    v_mfma_f32_32x32x16_bf16 v[112:127], a[12:15], a[12:15], 0
    v_accvgpr_write_b32 a36, 0
    s_and_b32 s46, s28, 1
    s_mul_i32 s46, s46, 4320
    s_lshl_b32 s47, s28, 5
    s_add_u32 s46, s46, s47
    s_add_u32 s46, s46, 104576
    v_and_b32 v35, 15, v32
    v_mfma_f32_32x32x16_bf16 v[128:143], a[12:15], a[12:15], 0
    v_accvgpr_write_b32 a40, 0
    v_mul_u32_u24 v35, 0x110, v35
    v_lshl_add_u32 v35, v47, 4, v35
    v_add_u32 v42, s46, v35
    v_and_b32 v33, 15, v32
    v_lshlrev_b32 v33, 7, v33
    v_lshl_add_u32 v33, v34, 4, v33
    v_bfe_u32 v35, v32, 4, 1
    v_lshl_add_u32 v13, v35, 5, v33
    s_lshl_b32 s46, s28, 12
    v_add_u32 v43, s46, v46
    s_add_u32 s46, s31, 12800
    v_mov_b32 v37, s46
    v_lshrrev_b32 v34, 5, v32
    v_and_b32 v33, 3, v32
    v_mul_u32_u24 v20, 0x110, v33
    v_add_u32 v20, s45, v20
    v_lshl_add_u32 v35, v34, 4, v20
    s_mov_b32 vcc_lo, 0xf0000f
    s_mov_b32 vcc_hi, 0xf0000f
    v_cndmask_b32 v28, v37, v35, vcc
    v_add_u32 v35, 0x1100, v35
    s_mov_b32 vcc_lo, 0xf0000f00
    s_mov_b32 vcc_hi, 0xf0000f00
    v_cndmask_b32 v29, v37, v35, vcc
    v_bfe_u32 v35, v32, 2, 2
    v_mul_u32_u24 v35, 0x110, v35
    v_bfe_u32 v36, v32, 4, 1
    v_lshl_add_u32 v35, v36, 5, v35
    v_and_b32 v19, 1, v32
    v_lshl_add_u32 v35, v19, 4, v35
    v_bfe_u32 v19, v32, 1, 1
    v_lshl_add_u32 v35, v19, 3, v35
    v_add_u32 v35, s45, v35
    s_mov_b32 vcc_lo, 0xffffffff
    s_mov_b32 vcc_hi, 0x0
    v_cndmask_b32 v30, v37, v35, vcc
    v_add_u32 v35, 0x1100, v35
    v_cndmask_b32 v31, v35, v37, vcc
    v_bfe_u32 v35, v32, 3, 1
    v_lshlrev_b32 v35, 5, v35
    v_lshl_add_u32 v35, v36, 4, v35
    v_lshl_add_u32 v19, v34, 3, v35
    v_add_u32 v20, v20, v19
    v_lshl_add_u32 v35, v34, 6, v35
    v_lshl_add_u32 v35, v33, 7, v35
    v_bfe_u32 v19, v32, 2, 1
    v_lshl_add_u32 v19, v19, 9, v35
    s_add_u32 s46, s31, 13312
    v_and_b32 v35, 15, v32
    v_lshlrev_b32 v35, 4, v35
    v_add_u32 v35, s46, v35
    v_lshl_add_u32 v17, v34, 8, v35
    v_lshl_add_u32 v17, v36, 3, v17
    v_and_b32 v35, 7, v32
    v_lshlrev_b32 v35, 4, v35
    v_add_u32 v35, s46, v35
    v_lshl_add_u32 v35, v34, 8, v35
    s_mov_b32 vcc_lo, 0xff0000ff
    s_mov_b32 vcc_hi, 0xff0000ff
    v_cndmask_b32 v18, v37, v35, vcc
    v_mov_b32 v35, 0x3f803f80
    s_mov_b32 vcc_lo, 0x10100101
    s_mov_b32 vcc_hi, 0x10100101
    v_cndmask_b32 v36, 0, v35, vcc
    s_mov_b32 vcc_lo, 0xffffffff
    s_mov_b32 vcc_hi, 0x0
    v_cndmask_b32_e64 v33, 0, v36, vcc
    v_cndmask_b32 v34, v36, 0, vcc
    v_accvgpr_write_b32 a20, v33
    v_accvgpr_write_b32 a21, v33
    v_accvgpr_write_b32 a24, v34
    v_accvgpr_write_b32 a25, v34
    v_accvgpr_write_b32 a4, v35
    v_accvgpr_write_b32 a5, v35
    v_accvgpr_write_b32 a6, v35
    v_accvgpr_write_b32 a7, v35
    v_accvgpr_write_b32 a10, 0
    v_accvgpr_write_b32 a11, 0
    v_accvgpr_write_b32 a18, 0
    v_accvgpr_write_b32 a19, 0
    v_accvgpr_write_b32 a22, 0
    v_accvgpr_write_b32 a23, 0
    v_accvgpr_write_b32 a26, 0
    v_accvgpr_write_b32 a27, 0
    v_mov_b32 v4, 0
    v_mov_b32 v5, 0
    v_mov_b32 v22, 0
    v_mov_b32 v23, 0
    v_add_u32 v56, s33, v40
    s_waitcnt vmcnt(9)
    s_nop 0
    v_lshlrev_b32 v64, 16, v48
    v_and_b32 v65, 0xffff0000, v48
    v_lshlrev_b32_e64 v66, 16, v49
    v_and_b32 v67, 0xffff0000, v49
    v_lshlrev_b32 v68, 16, v50
    v_and_b32 v69, 0xffff0000, v50
    v_lshlrev_b32 v70, 16, v51
    v_and_b32 v71, 0xffff0000, v51
    v_lshlrev_b32 v72, 16, v52
    v_and_b32 v73, 0xffff0000, v52
    v_lshlrev_b32 v74, 16, v53
    v_and_b32 v75, 0xffff0000, v53
    v_lshlrev_b32_e64 v76, 16, v54
    v_and_b32 v77, 0xffff0000, v54
    v_lshlrev_b32_e64 v78, 16, v55
    v_and_b32 v79, 0xffff0000, v55
    v_mul_f32 v64, 0x3e8293ee, v64
    v_mul_f32 v65, 0x3e8293ee, v65
    v_mul_f32 v66, 0x3e8293ee, v66
    v_mul_f32 v67, 0x3e8293ee, v67
    v_mul_f32 v68, 0x3e8293ee, v68
    v_mul_f32 v69, 0x3e8293ee, v69
    v_mul_f32 v70, 0x3e8293ee, v70
    v_mul_f32 v71, 0x3e8293ee, v71
    v_mul_f32 v72, 0x3e8293ee, v72
    v_mul_f32 v73, 0x3e8293ee, v73
    v_mul_f32 v74, 0x3e8293ee, v74
    v_mul_f32 v75, 0x3e8293ee, v75
    v_mul_f32 v76, 0x3e8293ee, v76
    v_mul_f32 v77, 0x3e8293ee, v77
    v_mul_f32 v78, 0x3e8293ee, v78
    v_mul_f32 v79, 0x3e8293ee, v79
    v_cvt_pk_bf16_f32 v48, v64, v65
    v_cvt_pk_bf16_f32 v49, v66, v67
    v_cvt_pk_bf16_f32 v50, v68, v69
    v_cvt_pk_bf16_f32 v51, v70, v71
    v_cvt_pk_bf16_f32 v52, v72, v73
    v_cvt_pk_bf16_f32 v53, v74, v75
    v_cvt_pk_bf16_f32 v54, v76, v77
    v_cvt_pk_bf16_f32 v55, v78, v79
    ds_write_b128 v56, v[48:51]
    ds_write_b128 v56, v[52:55] offset:1024
    s_mov_b64 exec, 0
    s_bitcmp1_b32 s28, 0
    s_cbranch_scc1 L_far0
    s_branch L_far1
L_back:
    s_mov_b64 exec, -1
    s_waitcnt lgkmcnt(0)
    s_waitcnt vmcnt(7)
    s_barrier
    ds_read_b64_tr_b16 a[48:49], v16 offset:4096
    ds_read_b64_tr_b16 a[50:51], v16 offset:4352
    ds_read_b64_tr_b16 a[52:53], v16 offset:5120
    s_add_u32 m0, s33, 0x6000
    ds_read_b64_tr_b16 a[54:55], v16 offset:5376
    s_mov_b64 s[20:21], s[12:13]
    ds_read_b64_tr_b16 a[56:57], v16 offset:6144
    buffer_load_dwordx4 v41, s[20:23], s34 offen lds
    ds_read_b64_tr_b16 a[58:59], v16 offset:6400
    ds_read_b64_tr_b16 a[60:61], v16 offset:7168
    ds_read_b64_tr_b16 a[62:63], v16 offset:7424
    ds_read_b64_tr_b16 a[64:65], v16 offset:12288
    ds_read_b64_tr_b16 a[66:67], v16 offset:12544
    ds_read_b64_tr_b16 a[68:69], v16 offset:13312
    ds_read_b64_tr_b16 a[70:71], v16 offset:13568
    ds_read_b64_tr_b16 a[72:73], v16 offset:14336
    buffer_load_dwordx4 v41, s[20:23], s35 offen offset:1024 lds
    ds_read_b64_tr_b16 a[74:75], v16 offset:14592
    s_add_u32 m0, s31, 4096
    ds_read_b64_tr_b16 a[76:77], v16 offset:15360
    ds_read_b64_tr_b16 a[78:79], v16 offset:15616
    ds_read_b64_tr_b16 a[80:81], v16 offset:8192
    ds_read_b64_tr_b16 a[82:83], v16 offset:8448
    ds_read_b64_tr_b16 a[84:85], v16 offset:9216
    ds_read_b64_tr_b16 a[86:87], v16 offset:9472
    ds_read_b64_tr_b16 a[88:89], v16 offset:10240
    ds_read_b64_tr_b16 a[90:91], v16 offset:10496
    ds_read_b64_tr_b16 a[92:93], v16 offset:11264
    ds_read_b64_tr_b16 a[94:95], v16 offset:11520
    ds_read_b64_tr_b16 a[96:97], v16
    ds_read_b64_tr_b16 a[98:99], v16 offset:256
    ds_read_b64_tr_b16 a[100:101], v16 offset:1024
    ds_read_b64_tr_b16 a[102:103], v16 offset:1280
    ds_read_b64_tr_b16 a[104:105], v16 offset:2048
    ds_read_b64_tr_b16 a[106:107], v16 offset:2304
    ds_read_b64_tr_b16 a[108:109], v16 offset:3072
    ds_read_b64_tr_b16 a[110:111], v16 offset:3328
    ds_read_b64_tr_b16 a[128:129], v43
    ds_read_b64_tr_b16 a[130:131], v43 offset:256
    ds_read_b64_tr_b16 a[136:137], v43 offset:8
    ds_read_b64_tr_b16 a[138:139], v43 offset:264
    ds_read_b64_tr_b16 a[132:133], v43 offset:2048
    ds_read_b64_tr_b16 a[134:135], v43 offset:2304
    ds_read_b64_tr_b16 a[140:141], v43 offset:2056
    ds_read_b64_tr_b16 a[142:143], v43 offset:2312
    s_waitcnt vmcnt(8)
    s_barrier
    ds_read_b128 a[112:115], v44
    ds_read_b128 a[116:119], v45
L_far0:
    s_cbranch_execz L_back
    s_waitcnt vmcnt(4)
    ds_read_b128 a[144:147], v6
    ds_read_b128 a[148:151], v7
    buffer_load_dwordx4 v38, s[16:19], s38 offen nt lds
    ds_read_b128 a[152:155], v8
    ds_read_b128 a[156:159], v9
    ds_read_b128 a[160:163], v24
    s_waitcnt lgkmcnt(6)
    v_mfma_f32_16x16x32_bf16 v[144:147], a[128:131], a[112:115], 0
    ds_read_b128 a[164:167], v25
    v_mfma_f32_16x16x32_bf16 v[148:151], a[136:139], a[112:115], 0
    buffer_load_dwordx4 v39, s[16:19], s38 offen offset:1024 nt lds
    s_waitcnt lgkmcnt(6)
    v_mfma_f32_16x16x32_bf16 v[144:147], a[132:135], a[116:119], v[144:147]
    ds_read_b128 a[168:171], v26
    v_mfma_f32_16x16x32_bf16 v[148:151], a[140:143], a[116:119], v[148:151]
    ds_read_b128 a[172:175], v27
    s_waitcnt lgkmcnt(7)
    v_mfma_f32_32x32x16_bf16 v[160:175], a[48:51], a[144:147], 0
    s_nop 0
    v_cvt_pk_bf16_f32 v144, v144, v145
    v_cvt_pk_bf16_f32 v145, v146, v147
    s_nop 1
    v_cvt_pk_bf16_f32 v146, v148, v149
    v_cvt_pk_bf16_f32 v147, v150, v151
    v_mfma_f32_32x32x16_bf16 v[224:239], a[64:67], a[144:147], 0
    ds_write_b128 v42, v[144:147]
    buffer_load_dwordx4 v38, s[16:19], s38 offen offset:2048 nt lds
    v_mfma_f32_32x32x16_bf16 v[240:255], a[96:99], a[144:147], 0
    s_waitcnt lgkmcnt(3)
    v_mfma_f32_32x32x16_bf16 v[160:175], a[52:55], a[148:151], v[160:175]
    v_mfma_f32_32x32x16_bf16 v[160:175], a[56:59], a[152:155], v[160:175]
    buffer_load_dwordx4 v39, s[16:19], s38 offen offset:3072 nt lds
    s_add_u32 m0, s31, 8192
    v_mfma_f32_32x32x16_bf16 v[160:175], a[60:63], a[156:159], v[160:175]
    v_mfma_f32_32x32x16_bf16 v[224:239], a[68:71], a[148:151], v[224:239]
    s_nop 4
    v_cvt_pk_bf16_f32 v176, v160, v161
    v_cvt_pk_bf16_f32 v177, v162, v163
    v_mfma_f32_32x32x16_bf16 v[224:239], a[72:75], a[152:155], v[224:239]
    v_cvt_pk_bf16_f32 v178, v164, v165
    v_cvt_pk_bf16_f32 v179, v166, v167
    v_cvt_pk_bf16_f32 v180, v168, v169
    v_cvt_pk_bf16_f32 v181, v170, v171
    v_cvt_pk_bf16_f32 v182, v172, v173
    v_cvt_pk_bf16_f32 v183, v174, v175
    v_mfma_f32_32x32x16_bf16 v[224:239], a[76:79], a[156:159], v[224:239]
    v_mfma_f32_32x32x16_bf16 v[240:255], a[100:103], a[148:151], v[240:255]
    s_nop 4
    v_cvt_pk_bf16_f32 v208, v224, v225
    v_cvt_pk_bf16_f32 v209, v226, v227
    v_mfma_f32_32x32x16_bf16 v[240:255], a[104:107], a[152:155], v[240:255]
    v_cvt_pk_bf16_f32 v210, v228, v229
    v_cvt_pk_bf16_f32 v211, v230, v231
    v_cvt_pk_bf16_f32 v212, v232, v233
    v_cvt_pk_bf16_f32 v213, v234, v235
    v_cvt_pk_bf16_f32 v214, v236, v237
    v_cvt_pk_bf16_f32 v215, v238, v239
    v_mfma_f32_32x32x16_bf16 v[240:255], a[108:111], a[156:159], v[240:255]
    v_mfma_f32_32x32x16_bf16 v[48:63], v[208:211], v[176:179], 0
    s_nop 4
    v_cvt_pk_bf16_f32 v184, v240, v241
    v_cvt_pk_bf16_f32 v185, v242, v243
    v_mfma_f32_32x32x16_bf16 v[48:63], v[212:215], v[180:183], v[48:63]
    v_cvt_pk_bf16_f32 v186, v244, v245
    v_cvt_pk_bf16_f32 v187, v246, v247
    v_cvt_pk_bf16_f32 v188, v248, v249
    v_cvt_pk_bf16_f32 v189, v250, v251
    v_cvt_pk_bf16_f32 v190, v252, v253
    v_cvt_pk_bf16_f32 v191, v254, v255
    v_mfma_f32_32x32x16_bf16 v[64:79], a[80:83], a[144:147], 0
    s_nop 4
    v_exp_f32 v48, v48
    v_mfma_f32_32x32x16_bf16 v[64:79], a[84:87], a[148:151], v[64:79]
    v_exp_f32 v49, v49
    v_exp_f32 v50, v50
    v_exp_f32 v51, v51
    v_mfma_f32_32x32x16_bf16 v[64:79], a[88:91], a[152:155], v[64:79]
    v_exp_f32 v52, v52
    v_exp_f32 v53, v53
    v_exp_f32 v54, v54
    v_mfma_f32_32x32x16_bf16 v[64:79], a[92:95], a[156:159], v[64:79]
    v_exp_f32 v55, v55
    v_exp_f32 v56, v56
    v_exp_f32 v57, v57
    v_smfmac_f32_16x16x64_bf16 a[32:35], a[0:3], v[48:55], v21
    v_exp_f32 v58, v58
    v_exp_f32 v59, v59
    v_exp_f32 v60, v60
    v_exp_f32 v61, v61
    v_exp_f32 v62, v62
    v_exp_f32_e64 v63, v63
    v_cvt_pk_bf16_f32 v144, v64, v65
    v_cvt_pk_bf16_f32 v145, v66, v67
    v_smfmac_f32_16x16x64_bf16 a[32:35], a[0:3], v[56:63], v21
    v_cvt_pk_bf16_f32 v146, v68, v69
    v_cvt_pk_bf16_f32 v147, v70, v71
    v_cvt_pk_bf16_f32 v148, v72, v73
    v_cvt_pk_bf16_f32 v149, v74, v75
    v_cvt_pk_bf16_f32 v150, v76, v77
    v_cvt_pk_bf16_f32 v151, v78, v79
    v_mfma_f32_32x32x16_bf16 v[64:79], v[144:147], v[184:187], 0
    s_nop 0
    v_mfma_f32_32x32x16_bf16 v[64:79], v[148:151], v[188:191], v[64:79]
    s_waitcnt vmcnt(6) lgkmcnt(0)
    s_barrier
    ds_read_b64_tr_b16 a[176:177], v16 offset:20480
    ds_read_b64_tr_b16 a[178:179], v16 offset:20736
    ds_read_b64_tr_b16 a[180:181], v16 offset:21504
    ds_read_b64_tr_b16 a[182:183], v16 offset:21760
    ds_read_b64_tr_b16 a[184:185], v16 offset:22528
    ds_read_b64_tr_b16 a[186:187], v16 offset:22784
    ds_read_b64_tr_b16 a[188:189], v16 offset:23552
    ds_read_b64_tr_b16 a[190:191], v16 offset:23808
    ds_read_b64_tr_b16 a[192:193], v16 offset:16384
    ds_read_b64_tr_b16 a[194:195], v16 offset:16640
    v_exp_f32 v64, v64
    v_exp_f32 v65, v65
    v_exp_f32 v66, v66
    v_exp_f32 v67, v67
    v_exp_f32 v68, v68
    v_exp_f32 v69, v69
    v_exp_f32 v70, v70
    v_exp_f32 v71, v71
    v_exp_f32 v72, v72
    v_exp_f32_e64 v73, v73
    v_smfmac_f32_16x16x64_bf16 a[28:31], a[0:3], v[64:71], v21
    s_waitcnt vmcnt(4)
    s_barrier
    ds_read_b64_tr_b16 a[196:197], v16 offset:17408
    ds_read_b64_tr_b16 a[198:199], v16 offset:17664
    ds_read_b64_tr_b16 a[200:201], v16 offset:18432
    v_exp_f32 v74, v74
    v_exp_f32 v75, v75
    v_exp_f32 v76, v76
    v_exp_f32 v77, v77
    v_exp_f32 v78, v78
    v_exp_f32_e64 v79, v79
    s_waitcnt lgkmcnt(3)
    v_mfma_f32_32x32x16_bf16 v[192:207], a[160:163], a[176:179], 0
    ds_read_b64_tr_b16 a[202:203], v16 offset:18688
    ds_read_b64_tr_b16 a[204:205], v16 offset:19456
    ds_read_b64_tr_b16 a[206:207], v16 offset:19712
    ds_read_b64_tr_b16 a[208:209], v43 offset:16384
    ds_read_b64_tr_b16 a[210:211], v43 offset:16640
    v_mfma_f32_32x32x16_bf16 v[192:207], a[164:167], a[180:183], v[192:207]
    ds_read_b64_tr_b16 a[216:217], v43 offset:16392
    ds_read_b64_tr_b16 a[218:219], v43 offset:16648
    ds_read_b64_tr_b16 a[212:213], v43 offset:18432
    v_mfma_f32_32x32x16_bf16 v[192:207], a[168:171], a[184:187], v[192:207]
    ds_read_b64_tr_b16 a[214:215], v43 offset:18688
    ds_read_b64_tr_b16 a[220:221], v43 offset:18440
    ds_read_b64_tr_b16 a[222:223], v43 offset:18696
    v_mfma_f32_32x32x16_bf16 v[192:207], a[172:175], a[188:191], v[192:207]
    v_mfma_f32_32x32x16_bf16 v[224:239], a[160:163], a[192:195], 0
    s_waitcnt lgkmcnt(11)
    s_nop 3
    v_cvt_pk_bf16_f32 v216, v192, v193
    v_cvt_pk_bf16_f32 v217, v194, v195
    v_mfma_f32_32x32x16_bf16 v[224:239], a[164:167], a[196:199], v[224:239]
    s_waitcnt lgkmcnt(7)
    v_cvt_pk_bf16_f32 v218, v196, v197
    v_cvt_pk_bf16_f32 v219, v198, v199
    v_cvt_pk_bf16_f32 v220, v200, v201
    v_cvt_pk_bf16_f32 v221, v202, v203
    v_cvt_pk_bf16_f32 v222, v204, v205
    v_cvt_pk_bf16_f32 v223, v206, v207
    v_mfma_f32_32x32x16_bf16 v[224:239], a[168:171], a[200:203], v[224:239]
    s_waitcnt lgkmcnt(1)
    v_mfma_f32_16x16x32_bf16 v[152:155], a[208:211], a[112:115], 0
    v_mfma_f32_16x16x32_bf16 v[156:159], a[216:219], a[112:115], 0
    v_mfma_f32_16x16x32_bf16 v[152:155], a[212:215], a[116:119], v[152:155]
    s_waitcnt lgkmcnt(0)
    v_mfma_f32_16x16x32_bf16 v[156:159], a[220:223], a[116:119], v[156:159]
    v_mfma_f32_32x32x16_bf16 v[224:239], a[172:175], a[204:207], v[224:239]
    s_nop 0
    v_cvt_pk_bf16_f32 v152, v152, v153
    v_cvt_pk_bf16_f32 v153, v154, v155
    s_nop 1
    v_cvt_pk_bf16_f32 v154, v156, v157
    v_cvt_pk_bf16_f32 v155, v158, v159
    v_smfmac_f32_32x32x32_bf16 v[96:111], v[216:219], v[48:55], v21
    ds_write_b128 v42, v[152:155] offset:128
    v_smfmac_f32_32x32x32_bf16 v[96:111], v[220:223], v[56:63], v21
    v_cvt_pk_bf16_f32 v152, v224, v225
    v_cvt_pk_bf16_f32 v153, v226, v227
    v_cvt_pk_bf16_f32 v154, v228, v229
    v_cvt_pk_bf16_f32 v155, v230, v231
    v_cvt_pk_bf16_f32 v156, v232, v233
    v_smfmac_f32_16x16x64_bf16 a[28:31], a[0:3], v[72:79], v21
    v_cvt_pk_bf16_f32 v157, v234, v235
    v_smfmac_f32_32x32x32_bf16 v[80:95], v[152:155], v[64:71], v21
    v_cvt_pk_bf16_f32 v158, v236, v237
    v_cvt_pk_bf16_f32 v159, v238, v239
    s_nop 1
    v_smfmac_f32_32x32x32_bf16 v[80:95], v[156:159], v[72:79], v21
    s_waitcnt vmcnt(0)
    buffer_load_dwordx4 v38, s[16:19], s39 offen nt lds
    ds_read_b128 a[224:227], v6 offset:4096
    ds_read_b128 a[228:231], v7 offset:4096
    ds_read_b128 a[232:235], v8 offset:4096
    ds_read_b128 a[236:239], v9 offset:4096
    ds_read_b128 a[240:243], v24 offset:4096
    buffer_load_dwordx4 v39, s[16:19], s39 offen offset:1024 nt lds
    ds_read_b128 a[244:247], v25 offset:4096
    ds_read_b128 a[248:251], v26 offset:4096
    ds_read_b128 a[252:255], v27 offset:4096
    s_waitcnt lgkmcnt(7)
    v_mfma_f32_32x32x16_bf16 v[160:175], a[80:83], a[224:227], 0
    buffer_load_dwordx4 v38, s[16:19], s39 offen offset:2048 nt lds
    v_mfma_f32_32x32x16_bf16 v[48:63], a[64:67], a[224:227], 0
    s_waitcnt lgkmcnt(4)
    v_mfma_f32_32x32x16_bf16 v[160:175], a[84:87], a[228:231], v[160:175]
    v_mfma_f32_32x32x16_bf16 v[160:175], a[88:91], a[232:235], v[160:175]
    buffer_load_dwordx4 v39, s[16:19], s39 offen offset:3072 nt lds
    ds_read_b128 a[120:123], v28
    ds_read_b128 a[124:127], v28 offset:32
    v_mfma_f32_32x32x16_bf16 v[160:175], a[92:95], a[236:239], v[160:175]
    ds_read_b128 a[112:115], v28 offset:64
    s_waitcnt lgkmcnt(3)
    v_mfma_f32_32x32x16_bf16 v[240:255], a[240:243], a[192:195], 0
    ds_read_b128 a[116:119], v28 offset:96
    ds_read_b128 a[128:131], v29
    v_mfma_f32_32x32x16_bf16 v[240:255], a[244:247], a[196:199], v[240:255]
    ds_read_b128 a[132:135], v29 offset:32
    v_cvt_pk_bf16_f32 v192, v160, v161
    v_cvt_pk_bf16_f32 v193, v162, v163
    v_cvt_pk_bf16_f32 v194, v164, v165
    v_cvt_pk_bf16_f32 v195, v166, v167
    v_cvt_pk_bf16_f32 v196, v168, v169
    v_mfma_f32_32x32x16_bf16 v[240:255], a[248:251], a[200:203], v[240:255]
    ds_read_b128 a[136:139], v29 offset:64
    v_cvt_pk_bf16_f32 v197, v170, v171
    v_cvt_pk_bf16_f32 v198, v172, v173
    v_cvt_pk_bf16_f32 v199, v174, v175
    s_barrier
    v_mfma_f32_32x32x16_bf16 v[32:47], v[192:195], v[184:187], 0
    ds_read_b128 a[140:143], v29 offset:96
    v_mfma_f32_32x32x16_bf16 v[32:47], v[196:199], v[188:191], v[32:47]
    v_mfma_f32_32x32x16_bf16 v[240:255], a[252:255], a[204:207], v[240:255]
    s_nop 4
    v_exp_f32 v32, v32
    v_mfma_f32_32x32x16_bf16 v[160:175], a[96:99], a[224:227], 0
    v_exp_f32 v33, v33
    v_exp_f32 v34, v34
    v_exp_f32 v35, v35
    v_mfma_f32_32x32x16_bf16 v[160:175], a[100:103], a[228:231], v[160:175]
    v_exp_f32 v36, v36
    v_exp_f32 v37, v37
    v_exp_f32 v38, v38
    v_mfma_f32_32x32x16_bf16 v[160:175], a[104:107], a[232:235], v[160:175]
    v_exp_f32 v39, v39
    v_exp_f32 v40, v40
    v_exp_f32 v41, v41
    v_mfma_f32_32x32x16_bf16 v[160:175], a[108:111], a[236:239], v[160:175]
    v_exp_f32 v42, v42
    v_exp_f32 v43, v43
    v_exp_f32 v44, v44
    v_smfmac_f32_16x16x64_bf16 a[28:31], a[0:3], v[32:39], v21
    v_exp_f32 v45, v45
    v_mfma_f32_32x32x16_bf16 v[48:63], a[68:71], a[228:231], v[48:63]
    v_exp_f32 v46, v46
    v_exp_f32 v47, v47
    v_cvt_pk_bf16_f32 v200, v240, v241
    v_cvt_pk_bf16_f32 v201, v242, v243
    v_smfmac_f32_16x16x64_bf16 a[28:31], a[0:3], v[40:47], v21
    ds_read_b64_tr_b16 a[208:209], v16 offset:28672
    v_mfma_f32_32x32x16_bf16 v[48:63], a[72:75], a[232:235], v[48:63]
    ds_read_b64_tr_b16 a[210:211], v16 offset:28928
    ds_read_b64_tr_b16 a[212:213], v16 offset:29696
    ds_read_b64_tr_b16 a[214:215], v16 offset:29952
    v_cvt_pk_bf16_f32 v202, v244, v245
    v_cvt_pk_bf16_f32 v203, v246, v247
    v_cvt_pk_bf16_f32 v204, v248, v249
    v_mfma_f32_32x32x16_bf16 v[48:63], a[76:79], a[236:239], v[48:63]
    ds_read_b64_tr_b16 a[216:217], v16 offset:30720
    ds_read_b64_tr_b16 a[218:219], v16 offset:30976
    ds_read_b64_tr_b16 a[220:221], v16 offset:31744
    v_cvt_pk_bf16_f32 v205, v250, v251
    v_cvt_pk_bf16_f32 v206, v252, v253
    v_cvt_pk_bf16_f32 v207, v254, v255
    v_mfma_f32_32x32x16_bf16 v[240:255], a[48:51], a[224:227], 0
    ds_read_b64_tr_b16 a[222:223], v16 offset:32000
    ds_read_b64_tr_b16 a[8:9], v30 offset:128
    ds_read_b64_tr_b16 a[16:17], v31 offset:128
    v_cvt_pk_bf16_f32 v224, v160, v161
    v_cvt_pk_bf16_f32 v225, v162, v163
    v_cvt_pk_bf16_f32 v226, v164, v165
    v_mfma_f32_32x32x16_bf16 v[240:255], a[52:55], a[228:231], v[240:255]
    v_cvt_pk_bf16_f32 v227, v166, v167
    v_cvt_pk_bf16_f32 v228, v168, v169
    v_cvt_pk_bf16_f32 v229, v170, v171
    v_cvt_pk_bf16_f32 v230, v172, v173
    v_cvt_pk_bf16_f32 v231, v174, v175
    v_cvt_pk_bf16_f32 v64, v48, v49
    v_mfma_f32_32x32x16_bf16 v[240:255], a[56:59], a[232:235], v[240:255]
    v_cvt_pk_bf16_f32 v65, v50, v51
    v_cvt_pk_bf16_f32 v66, v52, v53
    v_cvt_pk_bf16_f32 v67, v54, v55
    v_cvt_pk_bf16_f32 v68, v56, v57
    v_cvt_pk_bf16_f32 v69, v58, v59
    v_cvt_pk_bf16_f32 v70, v60, v61
    v_mfma_f32_32x32x16_bf16 v[240:255], a[60:63], a[236:239], v[240:255]
    v_cvt_pk_bf16_f32 v71, v62, v63
    v_smfmac_f32_32x32x32_bf16 v[80:95], v[200:203], v[32:39], v21
    s_nop 4
    v_cvt_pk_bf16_f32 v232, v240, v241
    v_cvt_pk_bf16_f32 v233, v242, v243
    v_smfmac_f32_32x32x32_bf16 v[80:95], v[204:207], v[40:47], v21
    s_waitcnt lgkmcnt(0)
    v_cvt_pk_bf16_f32 v234, v244, v245
    v_cvt_pk_bf16_f32 v235, v246, v247
    v_cvt_pk_bf16_f32 v236, v248, v249
    v_cvt_pk_bf16_f32 v237, v250, v251
    v_cvt_pk_bf16_f32 v238, v252, v253
    v_mfma_f32_16x16x32_bf16 v[28:31], a[112:115], v[184:187], 0
    v_cvt_pk_bf16_f32 v239, v254, v255
    v_mfma_f32_16x16x32_bf16 v[28:31], a[116:119], v[188:191], v[28:31]
    v_mfma_f32_16x16x32_bf16 v[28:31], a[136:139], v[176:179], v[28:31]
    v_mfma_f32_16x16x32_bf16 v[28:31], a[140:143], v[180:183], v[28:31]
    v_mfma_f32_32x32x16_bf16 v[32:47], a[240:243], a[176:179], 0
    s_nop 4
    v_exp_f32 v28, v28
    v_mfma_f32_32x32x16_bf16 v[32:47], a[244:247], a[180:183], v[32:47]
    v_exp_f32 v29, v29
    v_exp_f32 v30, v30
    v_exp_f32_e64 v31, v31
    v_mfma_f32_32x32x16_bf16 v[32:47], a[248:251], a[184:187], v[32:47]
    v_cvt_pk_bf16_f32 v2, v28, v29
    v_cvt_pk_bf16_f32 v3, v30, v31
    s_nop 1
    v_mfma_f32_32x32x16_bf16 v[80:95], a[8:11], v[2:5], v[80:95]
    v_mfma_f32_16x16x32_bf16 a[28:31], a[20:23], v[2:5], a[28:31]
    v_mfma_f32_32x32x16_bf16 v[96:111], a[16:19], v[2:5], v[96:111]
    v_mfma_f32_16x16x32_bf16 a[32:35], a[24:27], v[2:5], a[32:35]
    v_mfma_f32_32x32x16_bf16 v[32:47], a[252:255], a[188:191], v[32:47]
    v_mfma_f32_16x16x32_bf16 v[28:31], a[112:115], v[224:227], 0
    v_mfma_f32_16x16x32_bf16 v[28:31], a[116:119], v[228:231], v[28:31]
    s_nop 0
    v_cvt_pk_bf16_f32 v72, v32, v33
    v_cvt_pk_bf16_f32 v73, v34, v35
    v_mfma_f32_16x16x32_bf16 v[28:31], a[136:139], v[232:235], v[28:31]
    v_cvt_pk_bf16_f32 v74, v36, v37
    v_cvt_pk_bf16_f32 v75, v38, v39
    v_mfma_f32_16x16x32_bf16 v[28:31], a[140:143], v[236:239], v[28:31]
    v_cvt_pk_bf16_f32 v76, v40, v41
    v_cvt_pk_bf16_f32 v77, v42, v43
    v_cvt_pk_bf16_f32 v78, v44, v45
    v_cvt_pk_bf16_f32 v79, v46, v47
    v_mfma_f32_32x32x16_bf16 v[32:47], v[64:67], v[176:179], 0
    s_nop 2
    v_exp_f32 v28, v28
    v_exp_f32 v29, v29
    v_mfma_f32_32x32x16_bf16 v[32:47], v[68:71], v[180:183], v[32:47]
    v_exp_f32 v30, v30
    v_exp_f32 v31, v31
    v_cvt_pk_bf16_f32 v2, v28, v29
    v_cvt_pk_bf16_f32 v3, v30, v31
    s_nop 1
    v_mfma_f32_32x32x16_bf16 v[112:127], a[8:11], v[2:5], v[112:127]
    s_nop 4
    v_exp_f32 v32, v32
    v_mfma_f32_16x16x32_bf16 a[36:39], a[20:23], v[2:5], a[36:39]
    v_exp_f32 v33, v33
    v_mfma_f32_32x32x16_bf16 v[128:143], a[16:19], v[2:5], v[128:143]
    v_exp_f32 v34, v34
    v_exp_f32 v35, v35
    v_exp_f32 v36, v36
    v_mfma_f32_16x16x32_bf16 a[40:43], a[24:27], v[2:5], a[40:43]
    v_exp_f32 v37, v37
    v_exp_f32 v38, v38
    v_exp_f32 v39, v39
    v_exp_f32 v40, v40
    v_exp_f32 v41, v41
    v_smfmac_f32_32x32x32_bf16 v[96:111], v[72:75], v[32:39], v21
    s_waitcnt vmcnt(0)
    ds_read_b128 a[160:163], v6 offset:8192
    ds_read_b128 a[164:167], v7 offset:8192
    v_exp_f32 v42, v42
    v_exp_f32 v43, v43
    v_smfmac_f32_16x16x64_bf16 a[32:35], a[0:3], v[32:39], v21
    ds_read_b128 a[168:171], v8 offset:8192
    v_exp_f32 v44, v44
    v_exp_f32 v45, v45
    v_exp_f32 v46, v46
    v_exp_f32 v47, v47
    ds_read_b128 a[172:175], v9 offset:8192
    ds_read_b64_tr_b16 a[240:241], v16 offset:24576
    v_smfmac_f32_32x32x32_bf16 v[96:111], v[76:79], v[40:47], v21
    ds_read_b64_tr_b16 a[242:243], v16 offset:24832
    ds_read_b64_tr_b16 a[244:245], v16 offset:25600
    ds_read_b64_tr_b16 a[246:247], v16 offset:25856
    v_smfmac_f32_16x16x64_bf16 a[32:35], a[0:3], v[40:47], v21
    ds_read_b64_tr_b16 a[248:249], v16 offset:26624
    ds_read_b64_tr_b16 a[250:251], v16 offset:26880
    s_waitcnt lgkmcnt(8)
    v_mfma_f32_32x32x16_bf16 v[160:175], a[80:83], a[160:163], 0
    ds_read_b128 a[80:83], v24 offset:8192
    ds_read_b64_tr_b16 a[252:253], v16 offset:27648
    ds_read_b64_tr_b16 a[254:255], v16 offset:27904
    v_mfma_f32_32x32x16_bf16 v[160:175], a[84:87], a[164:167], v[160:175]
    ds_read_b128 a[84:87], v25 offset:8192
    s_waitcnt lgkmcnt(11)
    v_mfma_f32_32x32x16_bf16 v[160:175], a[88:91], a[168:171], v[160:175]
    ds_read_b128 a[88:91], v26 offset:8192
    s_waitcnt lgkmcnt(9)
    v_mfma_f32_32x32x16_bf16 v[160:175], a[92:95], a[172:175], v[160:175]
    ds_read_b128 a[92:95], v27 offset:8192
    s_nop 10
    v_cvt_pk_bf16_f32 v240, v160, v161
    v_cvt_pk_bf16_f32 v241, v162, v163
    v_cvt_pk_bf16_f32 v242, v164, v165
    v_cvt_pk_bf16_f32 v243, v166, v167
    v_cvt_pk_bf16_f32 v244, v168, v169
    v_cvt_pk_bf16_f32 v245, v170, v171
    v_mfma_f32_32x32x16_bf16 v[48:63], v[240:243], v[184:187], 0
    v_cvt_pk_bf16_f32 v246, v172, v173
    v_cvt_pk_bf16_f32 v247, v174, v175
    s_nop 1
    v_mfma_f32_32x32x16_bf16 v[48:63], v[244:247], v[188:191], v[48:63]
    s_waitcnt lgkmcnt(1)
    v_mfma_f32_32x32x16_bf16 v[160:175], a[80:83], a[192:195], 0
    s_nop 4
    v_exp_f32 v48, v48
    v_mfma_f32_32x32x16_bf16 v[160:175], a[84:87], a[196:199], v[160:175]
    v_exp_f32 v49, v49
    v_exp_f32 v50, v50
    v_exp_f32 v51, v51
    v_mfma_f32_32x32x16_bf16 v[160:175], a[88:91], a[200:203], v[160:175]
    s_waitcnt lgkmcnt(0)
    v_exp_f32 v52, v52
    v_exp_f32 v53, v53
    v_exp_f32 v54, v54
    v_mfma_f32_32x32x16_bf16 v[160:175], a[92:95], a[204:207], v[160:175]
    v_exp_f32 v55, v55
    v_exp_f32 v56, v56
    v_exp_f32 v57, v57
    v_smfmac_f32_16x16x64_bf16 a[28:31], a[0:3], v[48:55], v21
    v_exp_f32 v58, v58
    v_exp_f32 v59, v59
    v_exp_f32 v60, v60
    v_exp_f32 v61, v61
    v_exp_f32 v62, v62
    v_exp_f32 v63, v63
    v_cvt_pk_bf16_f32 v248, v160, v161
    v_cvt_pk_bf16_f32 v249, v162, v163
    v_smfmac_f32_16x16x64_bf16 a[28:31], a[0:3], v[56:63], v21
    v_cvt_pk_bf16_f32 v250, v164, v165
    v_cvt_pk_bf16_f32 v251, v166, v167
    v_cvt_pk_bf16_f32 v252, v168, v169
    v_cvt_pk_bf16_f32 v253, v170, v171
    v_smfmac_f32_32x32x32_bf16 v[80:95], v[248:251], v[48:55], v21
    v_cvt_pk_bf16_f32 v254, v172, v173
    v_cvt_pk_bf16_f32 v255, v174, v175
    s_nop 0
    v_accvgpr_read_b32 v15, a28
    v_rcp_f32 v14, v15
    v_smfmac_f32_32x32x32_bf16 v[80:95], v[252:255], v[56:63], v21
    v_max3_u32 v22, v22, v15, v14
    v_mfma_f32_32x32x16_bf16 v[160:175], a[64:67], a[160:163], 0
    s_nop 4
    v_mul_f32 v80, v14, v80
    v_mul_f32 v81, v14, v81
    v_mfma_f32_32x32x16_bf16 v[160:175], a[68:71], a[164:167], v[160:175]
    v_mul_f32 v82, v14, v82
    v_mul_f32 v83, v14, v83
    v_mul_f32 v84, v14, v84
    v_mul_f32 v85, v14, v85
    v_mul_f32 v86, v14, v86
    v_mul_f32_e64 v87, v14, v87
    v_mfma_f32_32x32x16_bf16 v[160:175], a[72:75], a[168:171], v[160:175]
    v_mul_f32 v88, v14, v88
    v_mul_f32 v89, v14, v89
    v_mul_f32 v90, v14, v90
    v_mul_f32 v91, v14, v91
    v_mul_f32 v92, v14, v92
    v_mul_f32 v93, v14, v93
    v_mfma_f32_32x32x16_bf16 v[160:175], a[76:79], a[172:175], v[160:175]
    v_mul_f32 v94, v14, v94
    v_mul_f32 v95, v14, v95
    s_nop 1
    v_mfma_f32_32x32x16_bf16 v[80:95], a[240:243], a[144:147], v[80:95]
    s_nop 4
    v_cvt_pk_bf16_f32 v48, v160, v161
    v_cvt_pk_bf16_f32 v49, v162, v163
    v_mfma_f32_32x32x16_bf16 v[80:95], a[244:247], a[148:151], v[80:95]
    v_cvt_pk_bf16_f32 v50, v164, v165
    v_cvt_pk_bf16_f32 v51, v166, v167
    v_cvt_pk_bf16_f32 v52, v168, v169
    v_cvt_pk_bf16_f32 v53, v170, v171
    v_cvt_pk_bf16_f32 v54, v172, v173
    v_cvt_pk_bf16_f32 v55, v174, v175
    v_mfma_f32_32x32x16_bf16 v[80:95], a[248:251], a[152:155], v[80:95]
    v_mfma_f32_32x32x16_bf16 v[80:95], a[252:255], a[156:159], v[80:95]
    v_mfma_f32_32x32x16_bf16 v[32:47], v[48:51], v[176:179], 0
    s_nop 4
    v_cvt_pk_bf16_f32 v80, v80, v81 clamp
    v_cvt_pk_bf16_f32 v81, v82, v83 clamp
    v_mfma_f32_32x32x16_bf16 v[32:47], v[52:55], v[180:183], v[32:47]
    v_cvt_pk_bf16_f32 v82, v84, v85 clamp
    v_cvt_pk_bf16_f32 v83, v86, v87 clamp
    v_cvt_pk_bf16_f32 v84, v88, v89 clamp
    v_cvt_pk_bf16_f32 v85, v90, v91 clamp
    v_cvt_pk_bf16_f32 v86, v92, v93 clamp
    v_cvt_pk_bf16_f32 v87, v94, v95 clamp
    v_mfma_f32_32x32x16_bf16 v[160:175], v[48:51], v[232:235], 0
    v_permlane16_swap_b32 v80, v84
    v_permlane16_swap_b32 v81, v85
    v_permlane16_swap_b32 v82, v86
    v_mfma_f32_32x32x16_bf16 v[160:175], v[52:55], v[236:239], v[160:175]
    v_permlane16_swap_b32 v83, v87
    v_pk_maximum3_f16 v23, v23, v80, v81
    v_pk_maximum3_f16 v23, v23, v82, v83
    v_pk_maximum3_f16 v23, v23, v84, v85
    v_pk_maximum3_f16 v23, v23, v86, v87
    v_mfma_f32_32x32x16_bf16 v[176:191], a[96:99], a[160:163], 0
    buffer_store_dwordx4 v[80:83], v13, s[24:27], 0 offen sc1 nt
    v_exp_f32 v32, v32
    v_exp_f32 v33, v33
    v_mfma_f32_32x32x16_bf16 v[176:191], a[100:103], a[164:167], v[176:191]
    buffer_store_dwordx4 v[84:87], v13, s[24:27], 0 offen offset:2048 sc1 nt
    v_exp_f32 v34, v34
    v_exp_f32 v35, v35
    v_mfma_f32_32x32x16_bf16 v[80:95], a[80:83], a[176:179], 0
    v_exp_f32 v36, v36
    v_exp_f32 v37, v37
    v_exp_f32 v38, v38
    v_mfma_f32_32x32x16_bf16 v[80:95], a[84:87], a[180:183], v[80:95]
    v_exp_f32 v39, v39
    v_exp_f32 v40, v40
    v_exp_f32 v41, v41
    v_mfma_f32_32x32x16_bf16 v[80:95], a[88:91], a[184:187], v[80:95]
    v_exp_f32 v42, v42
    v_exp_f32 v43, v43
    v_exp_f32 v44, v44
    v_mfma_f32_32x32x16_bf16 v[80:95], a[92:95], a[188:191], v[80:95]
    v_exp_f32 v45, v45
    v_exp_f32 v46, v46
    v_exp_f32 v47, v47
    v_smfmac_f32_16x16x64_bf16 a[32:35], a[0:3], v[32:39], v21
    v_exp_f32 v160, v160
    v_smfmac_f32_16x16x64_bf16 a[32:35], a[0:3], v[40:47], v21
    s_nop 0
    v_cvt_pk_bf16_f32 v56, v80, v81
    v_mfma_f32_32x32x16_bf16 v[176:191], a[104:107], a[168:171], v[176:191]
    v_cvt_pk_bf16_f32 v57, v82, v83
    v_cvt_pk_bf16_f32 v58, v84, v85
    v_cvt_pk_bf16_f32 v59, v86, v87
    v_cvt_pk_bf16_f32 v60, v88, v89
    v_cvt_pk_bf16_f32 v61, v90, v91
    v_cvt_pk_bf16_f32 v62, v92, v93
    v_smfmac_f32_32x32x32_bf16 v[96:111], v[56:59], v[32:39], v21
    v_cvt_pk_bf16_f32 v63, v94, v95
    v_accvgpr_read_b32 v15, a32
    v_rcp_f32 v14, v15
    v_exp_f32 v161, v161
    v_smfmac_f32_32x32x32_bf16 v[96:111], v[60:63], v[40:47], v21
    v_max3_u32 v22, v22, v15, v14
    v_exp_f32 v162, v162
    v_exp_f32_e64 v163, v163
    v_mfma_f32_32x32x16_bf16 v[80:95], v[64:67], v[232:235], 0
    v_exp_f32 v164, v164
    v_exp_f32 v165, v165
    v_exp_f32 v166, v166
    v_mfma_f32_32x32x16_bf16 v[80:95], v[68:71], v[236:239], v[80:95]
    v_mul_f32 v96, v14, v96
    v_mul_f32 v97, v14, v97
    v_mul_f32 v98, v14, v98
    v_mul_f32 v99, v14, v99
    v_mul_f32 v100, v14, v100
    v_mul_f32 v101, v14, v101
    v_mfma_f32_32x32x16_bf16 v[32:47], v[208:211], v[232:235], 0
    v_mul_f32 v102, v14, v102
    v_mul_f32 v103, v14, v103
    v_mul_f32 v104, v14, v104
    v_mul_f32 v105, v14, v105
    v_mul_f32 v106, v14, v106
    v_mul_f32 v107, v14, v107
    v_mfma_f32_32x32x16_bf16 v[32:47], v[212:215], v[236:239], v[32:47]
    v_mul_f32 v108, v14, v108
    v_mul_f32 v109, v14, v109
    v_mul_f32 v110, v14, v110
    v_mul_f32 v111, v14, v111
    v_exp_f32 v167, v167
    v_mfma_f32_32x32x16_bf16 v[176:191], a[108:111], a[172:175], v[176:191]
    v_exp_f32 v168, v168
    v_exp_f32 v169, v169
    v_exp_f32 v170, v170
    v_mfma_f32_32x32x16_bf16 v[96:111], a[208:211], a[144:147], v[96:111]
    v_exp_f32 v171, v171
    v_exp_f32 v172, v172
    v_exp_f32 v173, v173
    v_mfma_f32_32x32x16_bf16 v[96:111], a[212:215], a[148:151], v[96:111]
    v_exp_f32 v174, v174
    v_exp_f32 v175, v175
    v_exp_f32 v80, v80
    v_mfma_f32_32x32x16_bf16 v[96:111], a[216:219], a[152:155], v[96:111]
    v_exp_f32 v81, v81
    v_exp_f32 v82, v82
    v_exp_f32 v83, v83
    v_mfma_f32_32x32x16_bf16 v[96:111], a[220:223], a[156:159], v[96:111]
    v_exp_f32 v84, v84
    v_exp_f32 v85, v85
    v_exp_f32 v86, v86
    v_smfmac_f32_32x32x32_bf16 v[128:143], v[56:59], v[160:167], v21
    v_exp_f32 v87, v87
    v_exp_f32 v88, v88
    v_exp_f32 v89, v89
    v_smfmac_f32_16x16x64_bf16 a[40:43], a[0:3], v[160:167], v21
    v_cvt_pk_bf16_f32 v96, v96, v97 clamp
    v_smfmac_f32_32x32x32_bf16 v[128:143], v[60:63], v[168:175], v21
    v_cvt_pk_bf16_f32 v97, v98, v99 clamp
    v_cvt_pk_bf16_f32 v98, v100, v101 clamp
    v_cvt_pk_bf16_f32 v99, v102, v103 clamp
    v_cvt_pk_bf16_f32 v100, v104, v105 clamp
    v_cvt_pk_bf16_f32 v101, v106, v107 clamp
    v_smfmac_f32_16x16x64_bf16 a[40:43], a[0:3], v[168:175], v21
    v_cvt_pk_bf16_f32 v102, v108, v109 clamp
    v_smfmac_f32_32x32x32_bf16 v[128:143], v[72:75], v[80:87], v21
L_far1:
    s_cbranch_execz L_back
    v_cvt_pk_bf16_f32 v103, v110, v111 clamp
    v_permlane16_swap_b32 v96, v100
    v_permlane16_swap_b32 v97, v101
    v_smfmac_f32_16x16x64_bf16 a[40:43], a[0:3], v[80:87], v21
    v_permlane16_swap_b32 v98, v102
    v_mfma_f32_32x32x16_bf16 v[160:175], a[240:243], a[224:227], 0
    v_permlane16_swap_b32 v99, v103
    v_pk_maximum3_f16 v23, v23, v96, v97
    v_pk_maximum3_f16 v23, v23, v98, v99
    v_pk_maximum3_f16 v23, v23, v100, v101
    v_pk_maximum3_f16 v23, v23, v102, v103
    v_mfma_f32_32x32x16_bf16 v[160:175], a[244:247], a[228:231], v[160:175]
    buffer_store_dwordx4 v[96:99], v13, s[24:27], 0 offen offset:64 sc1 nt
    v_exp_f32 v90, v90
    v_exp_f32 v91, v91
    v_mfma_f32_32x32x16_bf16 v[160:175], a[248:251], a[232:235], v[160:175]
    buffer_store_dwordx4 v[100:103], v13, s[24:27], 0 offen offset:2112 sc1 nt
    v_exp_f32 v92, v92
    v_exp_f32_e64 v93, v93
    v_mfma_f32_32x32x16_bf16 v[96:111], v[240:243], v[224:227], 0
    v_exp_f32 v94, v94
    v_exp_f32 v95, v95
    v_exp_f32 v32, v32
    v_mfma_f32_32x32x16_bf16 v[96:111], v[244:247], v[228:231], v[96:111]
    v_exp_f32 v33, v33
    v_exp_f32 v34, v34
    v_exp_f32 v35, v35
    v_smfmac_f32_32x32x32_bf16 v[128:143], v[76:79], v[88:95], v21
    v_exp_f32 v36, v36
    v_exp_f32 v37, v37
    v_exp_f32_e64 v38, v38
    v_smfmac_f32_16x16x64_bf16 a[40:43], a[0:3], v[88:95], v21
    v_exp_f32 v39, v39
    v_mfma_f32_32x32x16_bf16 v[160:175], a[252:255], a[236:239], v[160:175]
    v_exp_f32 v40, v40
    v_exp_f32 v41, v41
    v_exp_f32 v42, v42
    v_smfmac_f32_32x32x32_bf16 v[128:143], v[216:219], v[32:39], v21
    v_exp_f32 v43, v43
    v_exp_f32 v44, v44
    v_exp_f32 v45, v45
    v_smfmac_f32_16x16x64_bf16 a[40:43], a[0:3], v[32:39], v21
    v_exp_f32 v46, v46
    v_mfma_f32_32x32x16_bf16 v[80:95], v[144:147], v[224:227], 0
    v_exp_f32_e64 v47, v47
    v_cvt_pk_bf16_f32 v232, v176, v177
    v_cvt_pk_bf16_f32 v233, v178, v179
    v_cvt_pk_bf16_f32 v234, v180, v181
    v_cvt_pk_bf16_f32 v235, v182, v183
    v_smfmac_f32_32x32x32_bf16 v[128:143], v[220:223], v[40:47], v21
    v_cvt_pk_bf16_f32 v236, v184, v185
    v_cvt_pk_bf16_f32 v237, v186, v187
    v_cvt_pk_bf16_f32 v238, v188, v189
    v_cvt_pk_bf16_f32 v239, v190, v191
    v_exp_f32 v96, v96
    v_smfmac_f32_16x16x64_bf16 a[40:43], a[0:3], v[40:47], v21
    v_exp_f32 v97, v97
    v_mfma_f32_32x32x16_bf16 v[80:95], v[148:151], v[228:231], v[80:95]
    v_exp_f32 v98, v98
    v_exp_f32 v99, v99
    v_exp_f32_e64 v100, v100
    v_mfma_f32_32x32x16_bf16 v[32:47], v[144:147], v[232:235], 0
    v_accvgpr_read_b32 v29, a40
    v_rcp_f32 v28, v29
    v_exp_f32 v101, v101
    v_max3_u32 v22, v22, v29, v28
    v_mfma_f32_32x32x16_bf16 v[32:47], v[148:151], v[236:239], v[32:47]
    v_mul_f32 v128, v28, v128
    v_mul_f32 v129, v28, v129
    v_mul_f32 v130, v28, v130
    v_mul_f32 v131, v28, v131
    v_mul_f32 v132, v28, v132
    v_mul_f32 v133, v28, v133
    v_mfma_f32_32x32x16_bf16 v[176:191], v[192:195], v[224:227], 0
    v_mul_f32 v134, v28, v134
    v_mul_f32 v135, v28, v135
    v_mul_f32 v136, v28, v136
    v_mul_f32 v137, v28, v137
    v_mul_f32 v138, v28, v138
    v_mul_f32 v139, v28, v139
    v_mfma_f32_32x32x16_bf16 v[176:191], v[196:199], v[228:231], v[176:191]
    v_mul_f32 v140, v28, v140
    v_mul_f32 v141, v28, v141
    v_mul_f32 v142, v28, v142
    v_mul_f32 v143, v28, v143
    v_exp_f32_e64 v102, v102
    v_mfma_f32_16x16x32_bf16 v[28:31], a[112:115], v[232:235], 0
    v_exp_f32 v103, v103
    v_mfma_f32_32x32x16_bf16 v[128:143], a[208:211], a[224:227], v[128:143]
    v_exp_f32 v104, v104
    v_exp_f32 v105, v105
    v_exp_f32 v106, v106
    v_mfma_f32_32x32x16_bf16 v[128:143], a[212:215], a[228:231], v[128:143]
    v_exp_f32 v107, v107
    v_exp_f32 v108, v108
    v_exp_f32 v109, v109
    v_mfma_f32_32x32x16_bf16 v[128:143], a[216:219], a[232:235], v[128:143]
    v_exp_f32 v110, v110
    v_exp_f32 v111, v111
    v_exp_f32 v80, v80
    v_mfma_f32_32x32x16_bf16 v[128:143], a[220:223], a[236:239], v[128:143]
    v_exp_f32 v81, v81
    v_exp_f32 v82, v82
    v_exp_f32 v83, v83
    v_mfma_f32_16x16x32_bf16 v[28:31], a[116:119], v[236:239], v[28:31]
    v_exp_f32 v84, v84
    v_exp_f32 v85, v85
    v_exp_f32 v86, v86
    v_exp_f32 v87, v87
    v_exp_f32 v88, v88
    v_cvt_pk_bf16_f32 v128, v128, v129 clamp
    v_smfmac_f32_32x32x32_bf16 v[112:127], v[152:155], v[80:87], v21
    v_cvt_pk_bf16_f32 v129, v130, v131 clamp
    v_cvt_pk_bf16_f32 v130, v132, v133 clamp
    v_cvt_pk_bf16_f32 v131, v134, v135 clamp
    v_cvt_pk_bf16_f32 v132, v136, v137 clamp
    v_cvt_pk_bf16_f32 v133, v138, v139 clamp
    v_smfmac_f32_16x16x64_bf16 a[36:39], a[0:3], v[80:87], v21
    v_cvt_pk_bf16_f32 v134, v140, v141 clamp
    v_cvt_pk_bf16_f32 v135, v142, v143 clamp
    v_permlane16_swap_b32 v128, v132
    v_permlane16_swap_b32 v129, v133
    v_permlane16_swap_b32 v130, v134
    v_permlane16_swap_b32 v131, v135
    v_pk_maximum3_f16 v23, v23, v128, v129
    v_pk_maximum3_f16 v23, v23, v130, v131
    v_pk_maximum3_f16 v23, v23, v132, v133
    v_pk_maximum3_f16 v23, v23, v134, v135
    v_exp_f32_e64 v89, v89
    buffer_store_dwordx4 v[128:131], v13, s[24:27], s38 offen offset:64 sc1 nt
    v_exp_f32 v90, v90
    v_exp_f32 v91, v91
    buffer_store_dwordx4 v[132:135], v13, s[24:27], s38 offen offset:2112 sc1 nt
    v_exp_f32 v92, v92
    v_mfma_f32_32x32x16_bf16 v[128:143], a[48:51], a[160:163], 0
    v_exp_f32 v93, v93
    v_exp_f32 v94, v94
    v_exp_f32 v95, v95
    v_mfma_f32_32x32x16_bf16 v[128:143], a[52:55], a[164:167], v[128:143]
    v_exp_f32 v32, v32
    v_exp_f32 v33, v33
    v_exp_f32 v34, v34
    v_smfmac_f32_32x32x32_bf16 v[112:127], v[156:159], v[88:95], v21
    v_exp_f32 v35, v35
    v_exp_f32 v36, v36
    v_exp_f32 v37, v37
    v_smfmac_f32_16x16x64_bf16 a[36:39], a[0:3], v[88:95], v21
    v_exp_f32 v38, v38
    v_smfmac_f32_32x32x32_bf16 v[112:127], v[248:251], v[96:103], v21
    v_exp_f32 v39, v39
    v_exp_f32 v40, v40
    v_exp_f32 v41, v41
    v_smfmac_f32_16x16x64_bf16 a[36:39], a[0:3], v[96:103], v21
    v_exp_f32 v42, v42
    v_smfmac_f32_32x32x32_bf16 v[112:127], v[252:255], v[104:111], v21
    v_exp_f32 v43, v43
    v_exp_f32 v44, v44
    v_exp_f32 v45, v45
    v_smfmac_f32_16x16x64_bf16 a[36:39], a[0:3], v[104:111], v21
    v_exp_f32 v46, v46
    v_mfma_f32_32x32x16_bf16 v[128:143], a[56:59], a[168:171], v[128:143]
    v_exp_f32 v47, v47
    v_exp_f32 v176, v176
    v_exp_f32 v177, v177
    v_mfma_f32_32x32x16_bf16 v[128:143], a[60:63], a[172:175], v[128:143]
    v_exp_f32 v178, v178
    v_exp_f32 v179, v179
    v_exp_f32 v180, v180
    v_exp_f32 v181, v181
    v_exp_f32 v182, v182
    v_exp_f32 v183, v183
    v_exp_f32 v184, v184
    v_exp_f32 v185, v185
    v_smfmac_f32_32x32x32_bf16 v[112:127], v[200:203], v[176:183], v21
    v_exp_f32 v186, v186
    v_exp_f32 v187, v187
    v_exp_f32 v188, v188
    v_smfmac_f32_16x16x64_bf16 a[36:39], a[0:3], v[176:183], v21
    v_exp_f32 v189, v189
    v_exp_f32 v190, v190
    v_exp_f32 v191, v191
    v_cvt_pk_bf16_f32 v224, v128, v129
    v_cvt_pk_bf16_f32 v225, v130, v131
    v_smfmac_f32_32x32x32_bf16 v[112:127], v[204:207], v[184:191], v21
    v_cvt_pk_bf16_f32 v226, v132, v133
    v_cvt_pk_bf16_f32 v227, v134, v135
    v_cvt_pk_bf16_f32 v228, v136, v137
    v_cvt_pk_bf16_f32 v229, v138, v139
    v_cvt_pk_bf16_f32 v230, v140, v141
    v_smfmac_f32_16x16x64_bf16 a[36:39], a[0:3], v[184:191], v21
    v_cvt_pk_bf16_f32 v231, v142, v143
    v_mfma_f32_16x16x32_bf16 v[28:31], a[136:139], v[224:227], v[28:31]
    s_nop 0
    v_mfma_f32_16x16x32_bf16 v[28:31], a[140:143], v[228:231], v[28:31]
    s_nop 0
    v_accvgpr_read_b32 v15, a36
    v_rcp_f32_e64 v14, v15
    v_mfma_f32_32x32x16_bf16 v[128:143], v[192:195], v[232:235], 0
    v_max3_u32 v22, v22, v15, v14
    v_fmac_f32 v160, v112, v14
    v_fmac_f32 v161, v113, v14
    v_fmac_f32 v162, v114, v14
    v_exp_f32 v28, v28
    v_mfma_f32_32x32x16_bf16 v[128:143], v[196:199], v[236:239], v[128:143]
    v_exp_f32 v29, v29
    v_exp_f32 v30, v30
    v_exp_f32_e64 v31, v31
    v_mfma_f32_16x16x32_bf16 v[184:187], v[144:147], a[120:123], 0
    v_cvt_pk_bf16_f32 v2, v28, v29
    v_cvt_pk_bf16_f32 v3, v30, v31
    v_mfma_f32_16x16x32_bf16 v[184:187], v[148:151], a[124:127], v[184:187]
    v_fmac_f32 v163, v115, v14
    v_fmac_f32 v164, v116, v14
    v_mfma_f32_32x32x16_bf16 v[80:95], a[8:11], v[2:5], 0
    v_fmac_f32 v165, v117, v14
    v_fmac_f32 v166, v118, v14
    v_fmac_f32 v167, v119, v14
    v_fmac_f32 v168, v120, v14
    v_fmac_f32 v169, v121, v14
    v_fmac_f32 v170, v122, v14
    v_mfma_f32_16x16x32_bf16 v[28:31], a[20:23], v[2:5], 0
    v_fmac_f32 v171, v123, v14
    v_fmac_f32 v172, v124, v14
    v_mfma_f32_32x32x16_bf16 v[96:111], a[16:19], v[2:5], 0
    v_fmac_f32 v173, v125, v14
    v_fmac_f32 v174, v126, v14
    v_fmac_f32_e64 v175, v127, v14
    v_cvt_pk_bf16_f32 v160, v160, v161 clamp
    v_cvt_pk_bf16_f32 v161, v162, v163 clamp
    v_cvt_pk_bf16_f32 v162, v164, v165 clamp
    v_mfma_f32_16x16x32_bf16 v[176:179], a[24:27], v[2:5], 0
    v_cvt_pk_bf16_f32 v163, v166, v167 clamp
    v_cvt_pk_bf16_f32 v164, v168, v169 clamp
    v_mfma_f32_32x32x16_bf16 v[112:127], v[240:243], v[232:235], 0
    v_cvt_pk_bf16_f32 v165, v170, v171 clamp
    v_cvt_pk_bf16_f32 v166, v172, v173 clamp
    v_cvt_pk_bf16_f32 v167, v174, v175 clamp
    v_permlane16_swap_b32 v160, v164
    v_permlane16_swap_b32 v161, v165
    v_mfma_f32_32x32x16_bf16 v[112:127], v[244:247], v[236:239], v[112:127]
    v_permlane16_swap_b32 v162, v166
    v_permlane16_swap_b32 v163, v167
    v_pk_maximum3_f16 v23, v23, v160, v161
    v_pk_maximum3_f16 v23, v23, v162, v163
    v_smfmac_f32_32x32x32_bf16 v[80:95], v[152:155], v[32:39], v21
    buffer_store_dwordx4 v[160:163], v13, s[24:27], s38 offen sc1 nt
    v_pk_maximum3_f16 v23, v23, v164, v165
    v_pk_maximum3_f16 v23, v23, v166, v167
    v_smfmac_f32_16x16x64_bf16 v[28:31], a[0:3], v[32:39], v21
    buffer_store_dwordx4 v[164:167], v13, s[24:27], s38 offen offset:2048 sc1 nt
    v_smfmac_f32_32x32x32_bf16 v[80:95], v[156:159], v[40:47], v21
    v_exp_f32 v128, v128
    v_exp_f32 v129, v129
    v_exp_f32 v130, v130
    v_mfma_f32_32x32x16_bf16 v[160:175], v[48:51], v[224:227], 0
    v_exp_f32 v131, v131
    v_exp_f32 v132, v132
    v_exp_f32 v133, v133
    v_mfma_f32_32x32x16_bf16 v[160:175], v[52:55], v[228:231], v[160:175]
    v_exp_f32 v134, v134
    v_exp_f32 v135, v135
    v_exp_f32 v136, v136
    v_smfmac_f32_16x16x64_bf16 v[28:31], a[0:3], v[40:47], v21
    v_exp_f32 v137, v137
    v_smfmac_f32_32x32x32_bf16 v[80:95], v[200:203], v[128:135], v21
    v_exp_f32 v138, v138
    v_exp_f32 v139, v139
    v_exp_f32 v140, v140
    v_smfmac_f32_16x16x64_bf16 v[28:31], a[0:3], v[128:135], v21
    v_exp_f32 v141, v141
    v_mfma_f32_32x32x16_bf16 v[32:47], a[240:243], a[160:163], 0
    v_exp_f32 v142, v142
    v_exp_f32 v143, v143
    v_exp_f32 v112, v112
    v_mfma_f32_32x32x16_bf16 v[32:47], a[244:247], a[164:167], v[32:47]
    v_exp_f32 v113, v113
    v_exp_f32 v114, v114
    v_exp_f32 v115, v115
    v_smfmac_f32_32x32x32_bf16 v[80:95], v[204:207], v[136:143], v21
    v_exp_f32 v116, v116
    v_exp_f32 v117, v117
    v_exp_f32 v118, v118
    v_smfmac_f32_16x16x64_bf16 v[28:31], a[0:3], v[136:143], v21
    v_exp_f32 v119, v119
    v_mfma_f32_32x32x16_bf16 v[32:47], a[248:251], a[168:171], v[32:47]
    v_exp_f32 v120, v120
    v_exp_f32 v121, v121
    v_exp_f32 v122, v122
    v_mfma_f32_32x32x16_bf16 v[32:47], a[252:255], a[172:175], v[32:47]
    v_exp_f32 v123, v123
    v_exp_f32 v124, v124
    v_exp_f32 v125, v125
    v_smfmac_f32_32x32x32_bf16 v[80:95], v[248:251], v[112:119], v21
    v_exp_f32 v126, v126
    v_exp_f32 v127, v127
    v_exp_f32_e64 v160, v160
    v_smfmac_f32_16x16x64_bf16 v[28:31], a[0:3], v[112:119], v21
    v_exp_f32 v161, v161
    v_smfmac_f32_32x32x32_bf16 v[80:95], v[252:255], v[120:127], v21
    v_exp_f32 v162, v162
    v_exp_f32 v163, v163
    v_exp_f32 v164, v164
    v_smfmac_f32_16x16x64_bf16 v[28:31], a[0:3], v[120:127], v21
    v_exp_f32 v165, v165
    v_mfma_f32_32x32x16_bf16 v[128:143], v[208:211], v[224:227], 0
    v_exp_f32 v166, v166
    v_exp_f32 v167, v167
    v_exp_f32 v168, v168
    v_mfma_f32_32x32x16_bf16 v[128:143], v[212:215], v[228:231], v[128:143]
    v_exp_f32 v169, v169
    v_exp_f32 v170, v170
    v_exp_f32 v171, v171
    v_smfmac_f32_32x32x32_bf16 v[96:111], v[56:59], v[160:167], v21
    v_exp_f32 v172, v172
    v_exp_f32 v173, v173
    v_exp_f32 v174, v174
    v_smfmac_f32_16x16x64_bf16 v[176:179], a[0:3], v[160:167], v21
    v_exp_f32 v175, v175
    v_mfma_f32_16x16x32_bf16 v[184:187], v[208:211], a[128:131], v[184:187]
    v_rcp_f32 v29, v28
    v_smfmac_f32_32x32x32_bf16 v[96:111], v[60:63], v[168:175], v21
    v_fmac_f32 v32, v80, v29
    v_fmac_f32 v33, v81, v29
    v_fmac_f32 v34, v82, v29
    v_fmac_f32 v35, v83, v29
    v_fmac_f32 v36, v84, v29
    v_smfmac_f32_16x16x64_bf16 v[176:179], a[0:3], v[168:175], v21
    v_fmac_f32 v37, v85, v29
    v_mfma_f32_16x16x32_bf16 v[184:187], v[212:215], a[132:135], v[184:187]
    v_fmac_f32 v38, v86, v29
    v_fmac_f32 v39, v87, v29
    v_mfma_f32_32x32x16_bf16 v[160:175], v[64:67], v[224:227], 0
    v_fmac_f32 v40, v88, v29
    v_fmac_f32 v41, v89, v29
    v_fmac_f32 v42, v90, v29
    v_fmac_f32 v43, v91, v29
    v_fmac_f32 v44, v92, v29
    v_fmac_f32 v45, v93, v29
    v_mfma_f32_32x32x16_bf16 v[160:175], v[68:71], v[228:231], v[160:175]
    v_fmac_f32 v46, v94, v29
    v_fmac_f32 v47, v95, v29
    v_cvt_pk_bf16_f32 v32, v32, v33 clamp
    v_cvt_pk_bf16_f32 v33, v34, v35 clamp
    v_cvt_pk_bf16_f32 v34, v36, v37 clamp
    v_cvt_pk_bf16_f32 v35, v38, v39 clamp
    v_mfma_f32_32x32x16_bf16 v[80:95], a[208:211], a[160:163], 0
    v_cvt_pk_bf16_f32 v36, v40, v41 clamp
    v_cvt_pk_bf16_f32 v37, v42, v43 clamp
    v_cvt_pk_bf16_f32 v38, v44, v45 clamp
    v_cvt_pk_bf16_f32 v39, v46, v47 clamp
    v_permlane16_swap_b32 v32, v36
    v_mfma_f32_32x32x16_bf16 v[80:95], a[212:215], a[164:167], v[80:95]
    v_permlane16_swap_b32 v33, v37
    v_permlane16_swap_b32 v34, v38
    v_permlane16_swap_b32 v35, v39
    v_mfma_f32_32x32x16_bf16 v[80:95], a[216:219], a[168:171], v[80:95]
    buffer_store_dwordx4 v[32:35], v13, s[24:27], s39 offen sc1 nt
    v_exp_f32 v128, v128
    v_exp_f32 v129, v129
    v_mfma_f32_32x32x16_bf16 v[80:95], a[220:223], a[172:175], v[80:95]
    buffer_store_dwordx4 v[36:39], v13, s[24:27], s39 offen offset:2048 sc1 nt
    v_exp_f32 v130, v130
    v_exp_f32 v131, v131
    v_mfma_f32_16x16x32_bf16 v[188:191], v[240:243], a[120:123], 0
    v_exp_f32 v132, v132
    v_mfma_f32_16x16x32_bf16 v[188:191], v[244:247], a[124:127], v[188:191]
    v_exp_f32 v133, v133
    v_mfma_f32_16x16x32_bf16 v[188:191], v[48:51], a[128:131], v[188:191]
    v_exp_f32 v134, v134
    v_mfma_f32_16x16x32_bf16 v[188:191], v[52:55], a[132:135], v[188:191]
    v_exp_f32 v135, v135
    v_mfma_f32_16x16x32_bf16 v[44:47], v[192:195], a[120:123], 0
    v_exp_f32 v136, v136
    v_smfmac_f32_32x32x32_bf16 v[96:111], v[216:219], v[128:135], v21
    v_exp_f32 v137, v137
    v_exp_f32 v138, v138
    v_exp_f32 v139, v139
    v_smfmac_f32_16x16x64_bf16 v[176:179], a[0:3], v[128:135], v21
    v_exp_f32 v140, v140
    v_mfma_f32_16x16x32_bf16 v[44:47], v[196:199], a[124:127], v[44:47]
    v_exp_f32 v141, v141
    v_mfma_f32_16x16x32_bf16 v[44:47], v[64:67], a[128:131], v[44:47]
    v_exp_f32 v142, v142
    v_mfma_f32_16x16x32_bf16 v[44:47], v[68:71], a[132:135], v[44:47]
    v_exp_f32 v143, v143
    v_exp_f32 v184, v184
    v_exp_f32 v185, v185
    v_smfmac_f32_32x32x32_bf16 v[96:111], v[220:223], v[136:143], v21
    v_exp_f32 v186, v186
    v_exp_f32 v187, v187
    v_cvt_pk_bf16_f32 v180, v184, v185
    v_smfmac_f32_16x16x64_bf16 v[176:179], a[0:3], v[136:143], v21
    v_cvt_pk_bf16_f32 v181, v186, v187
    v_exp_f32 v160, v160
    v_exp_f32 v161, v161
    v_exp_f32 v162, v162
    v_exp_f32 v163, v163
    v_exp_f32 v164, v164
    v_exp_f32 v165, v165
    v_exp_f32 v166, v166
    v_exp_f32 v167, v167
    v_exp_f32 v168, v168
    v_exp_f32 v169, v169
    v_smfmac_f32_32x32x32_bf16 v[96:111], v[72:75], v[160:167], v21
    ds_write_b64 v17, v[180:181]
    ds_read_b128 a[44:47], v18
    v_exp_f32 v170, v170
    v_smfmac_f32_16x16x64_bf16 v[176:179], a[0:3], v[160:167], v21
    ds_read_b128 a[192:195], v18 offset:128
    v_exp_f32 v171, v171
    v_exp_f32 v172, v172
    v_exp_f32 v173, v173
    v_exp_f32 v174, v174
    v_exp_f32 v175, v175
    v_exp_f32 v188, v188
    v_exp_f32 v189, v189
    v_smfmac_f32_32x32x32_bf16 v[96:111], v[76:79], v[168:175], v21
    v_exp_f32 v190, v190
    v_exp_f32 v191, v191
    v_cvt_pk_bf16_f32 v182, v188, v189
    v_smfmac_f32_16x16x64_bf16 v[176:179], a[0:3], v[168:175], v21
    v_cvt_pk_bf16_f32 v183, v190, v191
    v_exp_f32 v44, v44
    v_exp_f32 v45, v45
    v_mfma_f32_16x16x32_bf16 a[28:31], a[4:7], v[180:183], 0
    s_waitcnt lgkmcnt(1)
    v_exp_f32 v46, v46
    v_mfma_f32_16x16x32_bf16 v[112:115], v[152:155], a[44:47], 0
    s_nop 0
    v_rcp_f32 v177, v176
    v_mfma_f32_16x16x32_bf16 v[116:119], v[156:159], a[44:47], 0
    s_waitcnt lgkmcnt(0)
    v_fmac_f32 v80, v96, v177
    v_fmac_f32_e64 v81, v97, v177
    v_mfma_f32_16x16x32_bf16 v[120:123], v[216:219], a[192:195], 0
    v_fmac_f32 v82, v98, v177
    v_fmac_f32 v83, v99, v177
    v_mfma_f32_16x16x32_bf16 v[124:127], v[220:223], a[192:195], 0
    ds_write_b64 v17, v[182:183]
    v_mfma_f32_16x16x32_bf16 v[180:183], a[112:115], a[120:123], 0
    ds_read_b128 a[196:199], v18
    ds_read_b128 a[200:203], v18 offset:128
    v_mfma_f32_16x16x32_bf16 v[180:183], a[116:119], a[124:127], v[180:183]
    v_fmac_f32 v84, v100, v177
    v_fmac_f32 v85, v101, v177
    v_mfma_f32_16x16x32_bf16 v[180:183], a[136:139], a[128:131], v[180:183]
    v_fmac_f32 v86, v102, v177
    v_fmac_f32 v87, v103, v177
    v_mfma_f32_16x16x32_bf16 v[180:183], a[140:143], a[132:135], v[180:183]
    v_fmac_f32 v88, v104, v177
    v_fmac_f32 v89, v105, v177
    v_fmac_f32 v90, v106, v177
    v_fmac_f32 v91, v107, v177
    v_fmac_f32 v92, v108, v177
    v_fmac_f32 v93, v109, v177
    v_fmac_f32 v94, v110, v177
    v_fmac_f32 v95, v111, v177
    v_cvt_pk_bf16_f32 v80, v80, v81 clamp
    v_cvt_pk_bf16_f32 v81, v82, v83 clamp
    v_cvt_pk_bf16_f32 v82, v84, v85 clamp
    v_cvt_pk_bf16_f32 v83, v86, v87 clamp
    v_cvt_pk_bf16_f32 v84, v88, v89 clamp
    v_cvt_pk_bf16_f32 v85, v90, v91 clamp
    v_cvt_pk_bf16_f32 v86, v92, v93 clamp
    v_cvt_pk_bf16_f32 v87, v94, v95 clamp
    v_permlane16_swap_b32 v80, v84
    v_permlane16_swap_b32 v81, v85
    v_permlane16_swap_b32 v82, v86
    v_permlane16_swap_b32 v83, v87
    v_exp_f32 v47, v47
    v_cvt_pk_bf16_f32 v40, v44, v45
    v_cvt_pk_bf16_f32 v41, v46, v47
    v_exp_f32 v180, v180
    buffer_store_dwordx4 v[80:83], v13, s[24:27], s39 offen offset:64 sc1 nt
    ds_write_b64 v17, v[40:41]
    buffer_store_dwordx4 v[84:87], v13, s[24:27], s39 offen offset:2112 sc1 nt
    ds_read_b128 a[204:207], v18
    ds_read_b128 a[64:67], v18 offset:128
    v_exp_f32 v181, v181
    v_exp_f32 v182, v182
    v_exp_f32 v183, v183
    v_cvt_pk_bf16_f32 v42, v180, v181
    v_cvt_pk_bf16_f32 v43, v182, v183
    v_cndmask_b32 v42, 0, v42, s[68:69]
    v_cndmask_b32 v43, 0, v43, s[68:69]
    s_waitcnt lgkmcnt(3)
    v_mfma_f32_16x16x32_bf16 v[112:115], v[248:251], a[196:199], v[112:115]
    ds_write_b64 v17, v[42:43]
    v_mfma_f32_16x16x32_bf16 v[116:119], v[252:255], a[196:199], v[116:119]
    ds_read_b128 a[68:71], v18
    ds_read_b128 a[72:75], v18 offset:128
    v_mfma_f32_16x16x32_bf16 v[120:123], v[56:59], a[200:203], v[120:123]
    v_mfma_f32_16x16x32_bf16 v[124:127], v[60:63], a[200:203], v[124:127]
    ds_read_b64 v[188:189], v20 offset:192
    ds_read_b64 v[190:191], v20 offset:4544
    v_mfma_f32_16x16x32_bf16 a[28:31], a[4:7], v[40:43], a[28:31]
    s_waitcnt lgkmcnt(6)
    v_mfma_f32_16x16x32_bf16 v[112:115], v[200:203], a[204:207], v[112:115]
    v_mfma_f32_16x16x32_bf16 v[116:119], v[204:207], a[204:207], v[116:119]
    s_waitcnt lgkmcnt(5)
    v_accvgpr_read_b32 v185, a28
    v_mfma_f32_16x16x32_bf16 v[120:123], v[72:75], a[64:67], v[120:123]
    s_nop 0
    v_add_f32_dpp v184, v185, v185 row_shl:4 row_mask:0xf bank_mask:0xf bound_ctrl:0
    v_rcp_f32_e64 v185, v184
    v_mfma_f32_16x16x32_bf16 v[124:127], v[76:79], a[64:67], v[124:127]
    s_nop 0
    v_mov_b32_dpp v1, v185 row_ror:8 row_mask:0xf bank_mask:0xf
    v_cndmask_b32 v186, v185, v1, s[70:71]
    v_cndmask_b32 v187, v1, v185, s[70:71]
    s_waitcnt lgkmcnt(3)
    v_mfma_f32_16x16x32_bf16 v[112:115], a[8:11], a[68:71], v[112:115]
    s_waitcnt lgkmcnt(2)
    v_mfma_f32_16x16x32_bf16 v[120:123], a[16:19], a[72:75], v[120:123]
    s_waitcnt lgkmcnt(1)
    v_lshlrev_b32 v180, 16, v188
    v_and_b32 v181, 0xffff0000, v188
    v_lshlrev_b32 v182, 16, v189
    v_and_b32 v183, 0xffff0000, v189
    v_add_f32_dpp v112, v116, v112 row_shl:4 row_mask:0xf bank_mask:0xf bound_ctrl:0
    v_fmac_f32 v180, v112, v186
    v_add_f32_dpp v113, v117, v113 row_shl:4 row_mask:0xf bank_mask:0xf bound_ctrl:0
    v_fmac_f32_e64 v181, v113, v186
    v_add_f32_dpp v114, v118, v114 row_shl:4 row_mask:0xf bank_mask:0xf bound_ctrl:0
    v_fmac_f32 v182, v114, v186
    v_add_f32_dpp v115, v119, v115 row_shl:4 row_mask:0xf bank_mask:0xf bound_ctrl:0
    v_fmac_f32 v183, v115, v186
    v_cvt_pk_bf16_f32 v208, v180, v181 clamp
    v_cvt_pk_bf16_f32 v209, v182, v183 clamp
    v_add_f32_dpp v120, v124, v120 row_shl:4 row_mask:0xf bank_mask:0xf bound_ctrl:0
    v_add_f32_dpp v121, v125, v121 row_shl:4 row_mask:0xf bank_mask:0xf bound_ctrl:0
    v_add_f32_dpp v122, v126, v122 row_shl:4 row_mask:0xf bank_mask:0xf bound_ctrl:0
    v_add_f32_dpp v123, v127, v123 row_shl:4 row_mask:0xf bank_mask:0xf bound_ctrl:0
    s_waitcnt lgkmcnt(0)
    v_lshlrev_b32 v180, 16, v190
    v_and_b32 v181, 0xffff0000, v190
    v_lshlrev_b32 v182, 16, v191
    v_and_b32 v183, 0xffff0000, v191
    v_fmac_f32 v180, v120, v187
    v_fmac_f32 v181, v121, v187
    v_fmac_f32 v182, v122, v187
    v_fmac_f32_e64 v183, v123, v187
    v_cvt_pk_bf16_f32 v210, v180, v181 clamp
    v_cvt_pk_bf16_f32 v211, v182, v183 clamp
    s_nop 0
    v_permlane32_swap_b32 v208, v210
    v_permlane32_swap_b32 v209, v211
    buffer_store_dwordx4 v[208:211], v19, s[24:27], s40 offen sc1 nt
    v_max3_u32 v22, v22, v28, v29
    v_pk_maximum3_f16 v23, v23, v32, v33
    v_pk_maximum3_f16 v23, v23, v34, v35
    v_pk_maximum3_f16 v23, v23, v36, v37
    v_pk_maximum3_f16 v23, v23, v38, v39
    v_or_b32 v14, v216, v217
    v_or3_b32 v14, v14, v218, v219
    v_or3_b32 v14, v14, v220, v221
    v_or3_b32 v14, v14, v222, v223
    v_or3_b32 v14, v14, v152, v153
    v_or3_b32 v14, v14, v154, v155
    v_or3_b32 v14, v14, v156, v157
    v_or3_b32 v14, v14, v158, v159
    v_max3_u32 v22, v22, v176, v177
    v_pk_maximum3_f16 v23, v23, v80, v81
    v_pk_maximum3_f16 v23, v23, v82, v83
    v_pk_maximum3_f16 v23, v23, v84, v85
    v_pk_maximum3_f16 v23, v23, v86, v87
    v_or3_b32 v14, v14, v248, v249
    v_or3_b32 v14, v14, v250, v251
    v_or3_b32 v14, v14, v252, v253
    v_or3_b32 v14, v14, v254, v255
    v_or3_b32 v14, v14, v56, v57
    v_or3_b32 v14, v14, v58, v59
    v_or3_b32 v14, v14, v60, v61
    v_or3_b32 v14, v14, v62, v63
    v_or3_b32 v14, v14, v200, v201
    v_or3_b32 v14, v14, v202, v203
    v_or3_b32 v14, v14, v204, v205
    v_or3_b32 v14, v14, v206, v207
    v_or3_b32 v14, v14, v72, v73
    v_or3_b32 v14, v14, v74, v75
    v_or3_b32 v14, v14, v76, v77
    v_or3_b32 v14, v14, v78, v79
    v_pk_maximum3_f16 v15, v208, v209, v210
    v_pk_maximum3_f16 v15, v15, v211, v23
    v_cndmask_b32 v23, v23, v15, s[66:67]
    v_max_u32 v30, v184, v185
    v_cndmask_b32 v30, 0, v30, s[66:67]
    v_max_u32 v22, v22, v30
    v_accvgpr_read_b32 v28, a8
    v_accvgpr_read_b32 v29, a9
    v_accvgpr_read_b32 v30, a16
    v_accvgpr_read_b32 v31, a17
    v_or3_b32 v14, v14, v28, v29
    v_or3_b32 v14, v14, v30, v31
    v_add_u32 v28, 0x00800080, v23
    v_or3_b32 v14, v14, v28, v23
    v_and_b32 v28, 0x40004000, v14
    v_mul_u32_u24 v29, 0x18000, v28
    v_lshl_or_b32 v28, v28, 1, v29
    v_max_u32 v28, v22, v28
    v_cmp_lt_u32 vcc, 0x53800000, v28
    s_nop 4
    s_cbranch_vccnz L_slow
    s_endpgm
L_slow:
    s_waitcnt vmcnt(0) lgkmcnt(0)
    s_nop 15
    v_and_b32 v1, 63, v0
    v_and_b32 v2, 31, v1
    v_lshrrev_b32 v3, 5, v1
    v_bfe_u32 v4, v1, 2, 2
    v_lshl_add_u32 v4, v3, 3, v4
    v_lshlrev_b32 v4, 6, v4
    v_bfe_u32 v5, v1, 4, 1
    v_lshl_add_u32 v4, v5, 5, v4
    v_and_b32 v5, 1, v1
    v_lshl_add_u32 v4, v5, 4, v4
    v_bfe_u32 v5, v1, 1, 1
    v_lshl_add_u32 v17, v5, 3, v4
    v_bfe_u32 v4, v1, 1, 3
    v_xor_b32 v4, v4, v3
    v_lshlrev_b32 v4, 4, v4
    v_lshl_add_u32 v4, v2, 7, v4
    v_add_u32 v9, s31, v4
    v_xad_u32 v10, v4, 32, s31
    v_xad_u32 v11, v4, 64, s31
    v_xor_b32 v5, 32, v4
    v_xad_u32 v12, v5, 64, s31
    v_and_b32 v2, 31, v1
    v_lshrrev_b32 v3, 5, v1
    v_bfe_u32 v4, v1, 1, 2
    v_xor_b32 v4, v4, v3
    v_lshlrev_b32 v4, 4, v4
    v_lshl_add_u32 v4, v2, 6, v4
    v_add_u32 v18, s31, v4
    v_xad_u32 v19, v4, 32, s31
    v_lshrrev_b32 v4, 2, v1
    v_bfe_u32 v5, v1, 3, 2
    v_and_b32 v2, 3, v1
    v_xor_b32 v5, v5, v2
    v_lshlrev_b32 v5, 4, v5
    v_lshl_add_u32 v5, v4, 6, v5
    v_add_u32 v22, s31, v5
    v_lshlrev_b32 v2, 4, v2
    v_lshl_add_u32 v23, v4, 7, v2
    v_lshrrev_b32 v3, 5, v1
    v_and_b32 v4, 3, v1
    v_bfe_u32 v5, v1, 1, 1
    v_xor_b32 v5, v5, v3
    v_lshlrev_b32 v5, 4, v5
    v_lshl_add_u32 v5, v4, 7, v5
    s_mov_b32 vcc_lo, 0xf0000f
    s_mov_b32 vcc_hi, 0xf0000f
    v_mov_b32 v4, 0x200
    v_cndmask_b32 v5, v4, v5, vcc
    v_add_u32 v5, 0x3000, v5
    v_add_u32 v13, s31, v5
    v_xad_u32 v14, v5, 32, s31
    v_xad_u32 v15, v5, 64, s31
    v_xor_b32 v4, 32, v5
    v_xad_u32 v16, v4, 64, s31
    s_mov_b32 vcc_lo, 0xf0f00f0f
    s_mov_b32 vcc_hi, 0xf0f00f0f
    v_mov_b32 v4, 0x3f803f80
    v_cndmask_b32 v24, 0, v4, vcc
    v_cndmask_b32 v25, 0, v4, vcc
    v_cndmask_b32 v26, 0, v4, vcc
    v_cndmask_b32 v27, 0, v4, vcc
    v_mov_b32 v4, 0xff800000
    s_mov_b32 vcc_lo, 0x0
    s_mov_b32 vcc_hi, 0xffffffff
    v_cndmask_b32 v28, 0, v4, vcc
    v_cndmask_b32 v29, 0, v4, vcc
    v_cndmask_b32 v30, 0, v4, vcc
    v_cndmask_b32 v31, 0, v4, vcc
    v_mov_b32 v34, 0
    v_mov_b32 v35, 0
    s_mov_b32 s30, 0
L_slow_head:
    ds_read_b64_tr_b16 v[36:37], v17 offset:8192
    ds_read_b64_tr_b16 v[38:39], v17 offset:8448
    ds_read_b64_tr_b16 v[40:41], v17 offset:9216
    ds_read_b64_tr_b16 v[42:43], v17 offset:9472
    ds_read_b64_tr_b16 v[44:45], v17 offset:10240
    ds_read_b64_tr_b16 v[46:47], v17 offset:10496
    ds_read_b64_tr_b16 v[48:49], v17 offset:11264
    ds_read_b64_tr_b16 v[50:51], v17 offset:11520
    ds_read_b64_tr_b16 v[52:53], v17 offset:16384
    ds_read_b64_tr_b16 v[54:55], v17 offset:16640
    ds_read_b64_tr_b16 v[56:57], v17 offset:17408
    ds_read_b64_tr_b16 v[58:59], v17 offset:17664
    ds_read_b64_tr_b16 v[60:61], v17 offset:18432
    ds_read_b64_tr_b16 v[62:63], v17 offset:18688
    ds_read_b64_tr_b16 v[64:65], v17 offset:19456
    ds_read_b64_tr_b16 v[66:67], v17 offset:19712
    ds_read_b64_tr_b16 v[68:69], v17
    ds_read_b64_tr_b16 v[70:71], v17 offset:256
    ds_read_b64_tr_b16 v[72:73], v17 offset:1024
    ds_read_b64_tr_b16 v[74:75], v17 offset:1280
    ds_read_b64_tr_b16 v[76:77], v17 offset:2048
    ds_read_b64_tr_b16 v[78:79], v17 offset:2304
    ds_read_b64_tr_b16 v[80:81], v17 offset:3072
    ds_read_b64_tr_b16 v[82:83], v17 offset:3328
    ds_read_b64_tr_b16 v[84:85], v17 offset:24576
    ds_read_b64_tr_b16 v[86:87], v17 offset:24832
    ds_read_b64_tr_b16 v[88:89], v17 offset:25600
    ds_read_b64_tr_b16 v[90:91], v17 offset:25856
    ds_read_b64_tr_b16 v[92:93], v17 offset:26624
    ds_read_b64_tr_b16 v[94:95], v17 offset:26880
    ds_read_b64_tr_b16 v[96:97], v17 offset:27648
    ds_read_b64_tr_b16 v[98:99], v17 offset:27904
    ds_read_b128 v[224:227], v9
    ds_read_b128 v[228:231], v10
    ds_read_b128 v[232:235], v11
    ds_read_b128 v[236:239], v12
    s_waitcnt lgkmcnt(3)
    v_mfma_f32_32x32x16_bf16 v[192:207], v[36:39], v[224:227], 0
    s_waitcnt lgkmcnt(2)
    v_mfma_f32_32x32x16_bf16 v[192:207], v[40:43], v[228:231], v[192:207]
    s_waitcnt lgkmcnt(1)
    v_mfma_f32_32x32x16_bf16 v[192:207], v[44:47], v[232:235], v[192:207]
    s_waitcnt lgkmcnt(0)
    v_mfma_f32_32x32x16_bf16 v[192:207], v[48:51], v[236:239], v[192:207]
    v_mfma_f32_32x32x16_bf16 v[208:223], v[224:227], v[52:55], 0
    v_mfma_f32_32x32x16_bf16 v[208:223], v[228:231], v[56:59], v[208:223]
    v_mfma_f32_32x32x16_bf16 v[208:223], v[232:235], v[60:63], v[208:223]
    v_mfma_f32_32x32x16_bf16 v[208:223], v[236:239], v[64:67], v[208:223]
    v_cvt_pk_bf16_f32 v100, v192, v193
    v_cvt_pk_bf16_f32 v101, v194, v195
    v_cvt_pk_bf16_f32 v102, v196, v197
    v_cvt_pk_bf16_f32 v103, v198, v199
    v_cvt_pk_bf16_f32 v104, v200, v201
    v_cvt_pk_bf16_f32 v105, v202, v203
    v_cvt_pk_bf16_f32 v106, v204, v205
    v_cvt_pk_bf16_f32 v107, v206, v207
    v_mfma_f32_32x32x16_bf16 v[192:207], v[68:71], v[224:227], 0
    s_nop 2
    v_cvt_pk_bf16_f32 v132, v208, v209
    v_cvt_pk_bf16_f32 v133, v210, v211
    v_cvt_pk_bf16_f32 v134, v212, v213
    v_cvt_pk_bf16_f32 v135, v214, v215
    v_cvt_pk_bf16_f32 v136, v216, v217
    v_cvt_pk_bf16_f32 v137, v218, v219
    v_mfma_f32_32x32x16_bf16 v[192:207], v[72:75], v[228:231], v[192:207]
    v_cvt_pk_bf16_f32 v138, v220, v221
    v_cvt_pk_bf16_f32 v139, v222, v223
    ds_read_b128 v[224:227], v9 offset:4096
    ds_read_b128 v[228:231], v10 offset:4096
    v_mfma_f32_32x32x16_bf16 v[192:207], v[76:79], v[232:235], v[192:207]
    ds_read_b128 v[232:235], v11 offset:4096
    v_mfma_f32_32x32x16_bf16 v[192:207], v[80:83], v[236:239], v[192:207]
    ds_read_b128 v[236:239], v12 offset:4096
    s_nop 10
    v_cvt_pk_bf16_f32 v160, v192, v193
    v_cvt_pk_bf16_f32 v161, v194, v195
    v_cvt_pk_bf16_f32 v162, v196, v197
    v_cvt_pk_bf16_f32 v163, v198, v199
    v_cvt_pk_bf16_f32 v164, v200, v201
    v_cvt_pk_bf16_f32 v165, v202, v203
    v_cvt_pk_bf16_f32 v166, v204, v205
    v_cvt_pk_bf16_f32 v167, v206, v207
    s_waitcnt lgkmcnt(3)
    v_mfma_f32_32x32x16_bf16 v[192:207], v[36:39], v[224:227], 0
    s_waitcnt lgkmcnt(2)
    v_mfma_f32_32x32x16_bf16 v[192:207], v[40:43], v[228:231], v[192:207]
    s_waitcnt lgkmcnt(1)
    v_mfma_f32_32x32x16_bf16 v[192:207], v[44:47], v[232:235], v[192:207]
    s_waitcnt lgkmcnt(0)
    v_mfma_f32_32x32x16_bf16 v[192:207], v[48:51], v[236:239], v[192:207]
    v_mfma_f32_32x32x16_bf16 v[208:223], v[224:227], v[52:55], 0
    v_mfma_f32_32x32x16_bf16 v[208:223], v[228:231], v[56:59], v[208:223]
    v_mfma_f32_32x32x16_bf16 v[208:223], v[232:235], v[60:63], v[208:223]
    v_mfma_f32_32x32x16_bf16 v[208:223], v[236:239], v[64:67], v[208:223]
    v_cvt_pk_bf16_f32 v108, v192, v193
    v_cvt_pk_bf16_f32 v109, v194, v195
    v_cvt_pk_bf16_f32 v110, v196, v197
    v_cvt_pk_bf16_f32 v111, v198, v199
    v_cvt_pk_bf16_f32 v112, v200, v201
    v_cvt_pk_bf16_f32 v113, v202, v203
    v_cvt_pk_bf16_f32 v114, v204, v205
    v_cvt_pk_bf16_f32 v115, v206, v207
    v_mfma_f32_32x32x16_bf16 v[192:207], v[68:71], v[224:227], 0
    s_nop 2
    v_cvt_pk_bf16_f32 v140, v208, v209
    v_cvt_pk_bf16_f32 v141, v210, v211
    v_cvt_pk_bf16_f32 v142, v212, v213
    v_cvt_pk_bf16_f32 v143, v214, v215
    v_cvt_pk_bf16_f32 v144, v216, v217
    v_cvt_pk_bf16_f32 v145, v218, v219
    v_mfma_f32_32x32x16_bf16 v[192:207], v[72:75], v[228:231], v[192:207]
    v_cvt_pk_bf16_f32 v146, v220, v221
    v_cvt_pk_bf16_f32 v147, v222, v223
    ds_read_b128 v[224:227], v9 offset:8192
    ds_read_b128 v[228:231], v10 offset:8192
    v_mfma_f32_32x32x16_bf16 v[192:207], v[76:79], v[232:235], v[192:207]
    ds_read_b128 v[232:235], v11 offset:8192
    v_mfma_f32_32x32x16_bf16 v[192:207], v[80:83], v[236:239], v[192:207]
    ds_read_b128 v[236:239], v12 offset:8192
    s_nop 10
    v_cvt_pk_bf16_f32 v168, v192, v193
    v_cvt_pk_bf16_f32 v169, v194, v195
    v_cvt_pk_bf16_f32 v170, v196, v197
    v_cvt_pk_bf16_f32 v171, v198, v199
    v_cvt_pk_bf16_f32 v172, v200, v201
    v_cvt_pk_bf16_f32 v173, v202, v203
    v_cvt_pk_bf16_f32 v174, v204, v205
    v_cvt_pk_bf16_f32 v175, v206, v207
    s_waitcnt lgkmcnt(3)
    v_mfma_f32_32x32x16_bf16 v[192:207], v[36:39], v[224:227], 0
    s_waitcnt lgkmcnt(2)
    v_mfma_f32_32x32x16_bf16 v[192:207], v[40:43], v[228:231], v[192:207]
    s_waitcnt lgkmcnt(1)
    v_mfma_f32_32x32x16_bf16 v[192:207], v[44:47], v[232:235], v[192:207]
    s_waitcnt lgkmcnt(0)
    v_mfma_f32_32x32x16_bf16 v[192:207], v[48:51], v[236:239], v[192:207]
    v_mfma_f32_32x32x16_bf16 v[208:223], v[224:227], v[52:55], 0
    v_mfma_f32_32x32x16_bf16 v[208:223], v[228:231], v[56:59], v[208:223]
    v_mfma_f32_32x32x16_bf16 v[208:223], v[232:235], v[60:63], v[208:223]
    v_mfma_f32_32x32x16_bf16 v[208:223], v[236:239], v[64:67], v[208:223]
    v_cvt_pk_bf16_f32 v116, v192, v193
    v_cvt_pk_bf16_f32 v117, v194, v195
    v_cvt_pk_bf16_f32 v118, v196, v197
    v_cvt_pk_bf16_f32 v119, v198, v199
    v_cvt_pk_bf16_f32 v120, v200, v201
    v_cvt_pk_bf16_f32 v121, v202, v203
    v_cvt_pk_bf16_f32 v122, v204, v205
    v_cvt_pk_bf16_f32 v123, v206, v207
    v_mfma_f32_32x32x16_bf16 v[192:207], v[68:71], v[224:227], 0
    s_nop 2
    v_cvt_pk_bf16_f32 v148, v208, v209
    v_cvt_pk_bf16_f32 v149, v210, v211
    v_cvt_pk_bf16_f32 v150, v212, v213
    v_cvt_pk_bf16_f32 v151, v214, v215
    v_cvt_pk_bf16_f32 v152, v216, v217
    v_cvt_pk_bf16_f32 v153, v218, v219
    v_mfma_f32_32x32x16_bf16 v[192:207], v[72:75], v[228:231], v[192:207]
    v_cvt_pk_bf16_f32 v154, v220, v221
    v_cvt_pk_bf16_f32 v155, v222, v223
    ds_read_b128 v[224:227], v13
    ds_read_b128 v[228:231], v14
    v_mfma_f32_32x32x16_bf16 v[192:207], v[76:79], v[232:235], v[192:207]
    ds_read_b128 v[232:235], v15
    v_mfma_f32_32x32x16_bf16 v[192:207], v[80:83], v[236:239], v[192:207]
    ds_read_b128 v[236:239], v16
    s_nop 10
    v_cvt_pk_bf16_f32 v176, v192, v193
    v_cvt_pk_bf16_f32 v177, v194, v195
    v_cvt_pk_bf16_f32 v178, v196, v197
    v_cvt_pk_bf16_f32 v179, v198, v199
    v_cvt_pk_bf16_f32 v180, v200, v201
    v_cvt_pk_bf16_f32 v181, v202, v203
    v_cvt_pk_bf16_f32 v182, v204, v205
    v_cvt_pk_bf16_f32 v183, v206, v207
    s_waitcnt lgkmcnt(3)
    v_mfma_f32_32x32x16_bf16 v[192:207], v[36:39], v[224:227], 0
    s_waitcnt lgkmcnt(2)
    v_mfma_f32_32x32x16_bf16 v[192:207], v[40:43], v[228:231], v[192:207]
    s_waitcnt lgkmcnt(1)
    v_mfma_f32_32x32x16_bf16 v[192:207], v[44:47], v[232:235], v[192:207]
    s_waitcnt lgkmcnt(0)
    v_mfma_f32_32x32x16_bf16 v[192:207], v[48:51], v[236:239], v[192:207]
    v_mfma_f32_32x32x16_bf16 v[208:223], v[224:227], v[52:55], 0
    v_mfma_f32_32x32x16_bf16 v[208:223], v[228:231], v[56:59], v[208:223]
    v_mfma_f32_32x32x16_bf16 v[208:223], v[232:235], v[60:63], v[208:223]
    v_mfma_f32_32x32x16_bf16 v[208:223], v[236:239], v[64:67], v[208:223]
    v_cvt_pk_bf16_f32 v124, v192, v193
    v_cvt_pk_bf16_f32 v125, v194, v195
    v_cvt_pk_bf16_f32 v126, v196, v197
    v_cvt_pk_bf16_f32 v127, v198, v199
    v_cvt_pk_bf16_f32 v128, v200, v201
    v_cvt_pk_bf16_f32 v129, v202, v203
    v_cvt_pk_bf16_f32 v130, v204, v205
    v_cvt_pk_bf16_f32 v131, v206, v207
    v_mfma_f32_32x32x16_bf16 v[192:207], v[68:71], v[224:227], 0
    s_nop 2
    v_cvt_pk_bf16_f32 v156, v208, v209
    v_cvt_pk_bf16_f32 v157, v210, v211
    v_cvt_pk_bf16_f32 v158, v212, v213
    v_cvt_pk_bf16_f32 v159, v214, v215
    ds_read_b128 v[68:71], v9
    v_mfma_f32_32x32x16_bf16 v[192:207], v[72:75], v[228:231], v[192:207]
    ds_read_b128 v[72:75], v10
    v_mfma_f32_32x32x16_bf16 v[192:207], v[76:79], v[232:235], v[192:207]
    ds_read_b128 v[76:79], v11
    v_mfma_f32_32x32x16_bf16 v[192:207], v[80:83], v[236:239], v[192:207]
    ds_read_b128 v[80:83], v12
    v_mfma_f32_32x32x16_bf16 v[208:223], v[108:111], v[160:163], 0
    v_mfma_f32_32x32x16_bf16 v[208:223], v[112:115], v[164:167], v[208:223]
    v_mfma_f32_32x32x16_bf16 v[224:239], v[116:119], v[160:163], 0
    v_mfma_f32_32x32x16_bf16 v[224:239], v[120:123], v[164:167], v[224:239]
    v_mfma_f32_16x16x32_bf16 v[240:243], v[124:127], v[160:163], v[28:31]
    v_mfma_f32_16x16x32_bf16 v[240:243], v[128:131], v[164:167], v[240:243]
    s_waitcnt lgkmcnt(3)
    v_mfma_f32_32x32x16_bf16 v[52:67], v[84:87], v[68:71], 0
    v_cvt_pk_bf16_f32 v184, v192, v193
    v_cvt_pk_bf16_f32 v185, v194, v195
    v_cvt_pk_bf16_f32 v186, v196, v197
    v_cvt_pk_bf16_f32 v187, v198, v199
    v_cvt_pk_bf16_f32 v188, v200, v201
    v_cvt_pk_bf16_f32 v189, v202, v203
    v_cvt_pk_bf16_f32 v190, v204, v205
    v_cvt_pk_bf16_f32 v191, v206, v207
    v_mfma_f32_32x32x16_bf16 v[192:207], v[100:103], v[160:163], 0
    v_mfma_f32_32x32x16_bf16 v[192:207], v[104:107], v[164:167], v[192:207]
    s_waitcnt lgkmcnt(2)
    v_mfma_f32_32x32x16_bf16 v[52:67], v[88:91], v[72:75], v[52:67]
    s_waitcnt lgkmcnt(1)
    v_mfma_f32_32x32x16_bf16 v[52:67], v[92:95], v[76:79], v[52:67]
    s_waitcnt lgkmcnt(0)
    v_mfma_f32_32x32x16_bf16 v[52:67], v[96:99], v[80:83], v[52:67]
    v_max_f32 v248, v192, v193
    v_max3_f32 v248, v248, v194, v195
    v_max3_f32 v248, v248, v196, v197
    v_max3_f32 v248, v248, v198, v199
    v_max3_f32 v248, v248, v200, v201
    v_max3_f32 v248, v248, v202, v203
    v_max3_f32 v248, v248, v204, v205
    v_max3_f32 v248, v248, v206, v207
    v_max3_f32 v248, v248, v208, v209
    v_max3_f32 v248, v248, v210, v211
    v_max3_f32 v248, v248, v212, v213
    v_max3_f32 v248, v248, v214, v215
    v_max3_f32 v248, v248, v216, v217
    v_max3_f32 v248, v248, v218, v219
    v_max3_f32 v248, v248, v220, v221
    v_max3_f32 v248, v248, v222, v223
    v_max3_f32 v248, v248, v224, v225
    v_max3_f32 v248, v248, v226, v227
    v_max3_f32 v248, v248, v228, v229
    v_max3_f32 v248, v248, v230, v231
    v_max3_f32 v248, v248, v232, v233
    v_max3_f32 v248, v248, v234, v235
    v_max3_f32 v248, v248, v236, v237
    v_max3_f32 v248, v248, v238, v239
    v_max3_f32 v248, v248, v240, v241
    v_max3_f32 v248, v248, v242, v243
    v_mov_b32 v249, v248
    ds_read_b128 v[68:71], v9 offset:4096
    ds_read_b128 v[72:75], v10 offset:4096
    v_permlane32_swap_b32 v248, v249
    v_max_f32 v248, v248, v249
    v_sub_f32 v192, v192, v248
    v_exp_f32 v192, v192
    v_sub_f32 v193, v193, v248
    v_exp_f32 v193, v193
    v_sub_f32 v194, v194, v248
    v_exp_f32 v194, v194
    v_sub_f32 v195, v195, v248
    v_exp_f32 v195, v195
    v_sub_f32 v196, v196, v248
    v_exp_f32 v196, v196
    v_sub_f32 v197, v197, v248
    v_exp_f32 v197, v197
    v_sub_f32 v198, v198, v248
    v_exp_f32 v198, v198
    v_sub_f32 v199, v199, v248
    v_exp_f32 v199, v199
    v_sub_f32 v200, v200, v248
    v_exp_f32 v200, v200
    v_sub_f32 v201, v201, v248
    v_exp_f32 v201, v201
    v_sub_f32 v202, v202, v248
    v_exp_f32 v202, v202
    v_sub_f32 v203, v203, v248
    v_exp_f32 v203, v203
    v_sub_f32 v204, v204, v248
    v_exp_f32 v204, v204
    v_sub_f32 v205, v205, v248
    v_exp_f32 v205, v205
    v_sub_f32 v206, v206, v248
    v_exp_f32 v206, v206
    v_sub_f32 v207, v207, v248
    v_exp_f32 v207, v207
    v_sub_f32 v208, v208, v248
    v_exp_f32 v208, v208
    v_sub_f32 v209, v209, v248
    v_exp_f32 v209, v209
    v_sub_f32 v210, v210, v248
    v_exp_f32 v210, v210
    v_sub_f32 v211, v211, v248
    v_exp_f32 v211, v211
    v_sub_f32 v212, v212, v248
    v_exp_f32 v212, v212
    v_sub_f32 v213, v213, v248
    v_exp_f32 v213, v213
    v_sub_f32 v214, v214, v248
    v_exp_f32 v214, v214
    v_sub_f32 v215, v215, v248
    v_exp_f32 v215, v215
    v_sub_f32 v216, v216, v248
    v_exp_f32 v216, v216
    v_sub_f32 v217, v217, v248
    v_exp_f32 v217, v217
    v_sub_f32 v218, v218, v248
    v_exp_f32 v218, v218
    v_sub_f32 v219, v219, v248
    v_exp_f32 v219, v219
    v_sub_f32 v220, v220, v248
    v_exp_f32 v220, v220
    v_sub_f32 v221, v221, v248
    v_exp_f32 v221, v221
    v_sub_f32 v222, v222, v248
    v_exp_f32 v222, v222
    v_sub_f32 v223, v223, v248
    v_exp_f32 v223, v223
    v_sub_f32 v224, v224, v248
    v_exp_f32 v224, v224
    v_sub_f32 v225, v225, v248
    v_exp_f32 v225, v225
    v_sub_f32 v226, v226, v248
    v_exp_f32 v226, v226
    v_sub_f32 v227, v227, v248
    v_exp_f32 v227, v227
    v_sub_f32 v228, v228, v248
    v_exp_f32 v228, v228
    v_sub_f32 v229, v229, v248
    v_exp_f32 v229, v229
    v_sub_f32 v230, v230, v248
    v_exp_f32 v230, v230
    v_sub_f32 v231, v231, v248
    v_exp_f32 v231, v231
    v_sub_f32 v232, v232, v248
    v_exp_f32 v232, v232
    v_sub_f32 v233, v233, v248
    v_exp_f32 v233, v233
    v_sub_f32 v234, v234, v248
    v_exp_f32 v234, v234
    v_sub_f32 v235, v235, v248
    v_exp_f32 v235, v235
    v_sub_f32 v236, v236, v248
    v_exp_f32 v236, v236
    v_sub_f32 v237, v237, v248
    v_exp_f32 v237, v237
    v_sub_f32 v238, v238, v248
    v_exp_f32 v238, v238
    v_sub_f32 v239, v239, v248
    v_exp_f32 v239, v239
    v_sub_f32 v240, v240, v248
    v_exp_f32 v240, v240
    v_sub_f32 v241, v241, v248
    v_exp_f32 v241, v241
    v_sub_f32 v242, v242, v248
    v_exp_f32 v242, v242
    v_sub_f32 v243, v243, v248
    v_exp_f32 v243, v243
    v_cvt_pk_bf16_f32 v192, v192, v193
    v_cvt_pk_bf16_f32 v193, v194, v195
    v_cvt_pk_bf16_f32 v194, v196, v197
    v_cvt_pk_bf16_f32 v195, v198, v199
    v_cvt_pk_bf16_f32 v200, v200, v201
    v_cvt_pk_bf16_f32 v201, v202, v203
    v_cvt_pk_bf16_f32 v202, v204, v205
    v_cvt_pk_bf16_f32 v203, v206, v207
    v_cvt_pk_bf16_f32 v208, v208, v209
    v_cvt_pk_bf16_f32 v209, v210, v211
    v_cvt_pk_bf16_f32 v210, v212, v213
    v_cvt_pk_bf16_f32 v211, v214, v215
    v_cvt_pk_bf16_f32 v216, v216, v217
    v_cvt_pk_bf16_f32 v217, v218, v219
    v_cvt_pk_bf16_f32 v218, v220, v221
    v_cvt_pk_bf16_f32 v219, v222, v223
    v_cvt_pk_bf16_f32 v224, v224, v225
    v_cvt_pk_bf16_f32 v225, v226, v227
    v_cvt_pk_bf16_f32 v226, v228, v229
    v_cvt_pk_bf16_f32 v227, v230, v231
    v_cvt_pk_bf16_f32 v232, v232, v233
    v_cvt_pk_bf16_f32 v233, v234, v235
    v_cvt_pk_bf16_f32 v234, v236, v237
    v_cvt_pk_bf16_f32 v235, v238, v239
    v_cvt_pk_bf16_f32 v32, v240, v241
    v_cvt_pk_bf16_f32 v33, v242, v243
    v_mfma_f32_32x32x16_bf16 v[36:51], v[132:135], v[192:195], 0
    ds_read_b128 v[76:79], v11 offset:4096
    ds_read_b128 v[80:83], v12 offset:4096
    v_mfma_f32_16x16x32_bf16 v[244:247], v[24:27], v[192:195], 0
    v_mfma_f32_32x32x16_bf16 v[36:51], v[136:139], v[200:203], v[36:51]
    v_mfma_f32_16x16x32_bf16 v[244:247], v[24:27], v[200:203], v[244:247]
    v_mfma_f32_32x32x16_bf16 v[36:51], v[140:143], v[208:211], v[36:51]
    v_mfma_f32_16x16x32_bf16 v[244:247], v[24:27], v[208:211], v[244:247]
    v_mfma_f32_32x32x16_bf16 v[36:51], v[144:147], v[216:219], v[36:51]
    v_mfma_f32_16x16x32_bf16 v[244:247], v[24:27], v[216:219], v[244:247]
    v_mfma_f32_32x32x16_bf16 v[36:51], v[148:151], v[224:227], v[36:51]
    v_mfma_f32_16x16x32_bf16 v[244:247], v[24:27], v[224:227], v[244:247]
    v_mfma_f32_32x32x16_bf16 v[36:51], v[152:155], v[232:235], v[36:51]
    v_mfma_f32_16x16x32_bf16 v[244:247], v[24:27], v[232:235], v[244:247]
    v_mfma_f32_32x32x16_bf16 v[36:51], v[156:159], v[32:35], v[36:51]
    v_mfma_f32_16x16x32_bf16 v[244:247], v[24:27], v[32:35], v[244:247]
    v_mfma_f32_32x32x16_bf16 v[192:207], v[100:103], v[168:171], 0
    v_mfma_f32_32x32x16_bf16 v[192:207], v[104:107], v[172:175], v[192:207]
    v_rcp_f32 v250, v244
    v_mfma_f32_32x32x16_bf16 v[208:223], v[108:111], v[168:171], 0
    v_fma_f32 v36, v36, v250, v52
    v_fma_f32 v37, v37, v250, v53
    v_fma_f32 v38, v38, v250, v54
    v_fma_f32 v39, v39, v250, v55
    v_fma_f32 v40, v40, v250, v56
    v_fma_f32 v41, v41, v250, v57
    v_fma_f32 v42, v42, v250, v58
    v_fma_f32 v43, v43, v250, v59
    v_fma_f32 v44, v44, v250, v60
    v_fma_f32 v45, v45, v250, v61
    v_fma_f32 v46, v46, v250, v62
    v_fma_f32 v47, v47, v250, v63
    v_fma_f32 v48, v48, v250, v64
    v_fma_f32 v49, v49, v250, v65
    v_fma_f32 v50, v50, v250, v66
    v_fma_f32 v51, v51, v250, v67
    v_cvt_pk_bf16_f32 v36, v36, v37
    v_cvt_pk_bf16_f32 v37, v38, v39
    v_cvt_pk_bf16_f32 v38, v40, v41
    v_cvt_pk_bf16_f32 v39, v42, v43
    v_cvt_pk_bf16_f32 v40, v44, v45
    v_cvt_pk_bf16_f32 v41, v46, v47
    v_cvt_pk_bf16_f32 v42, v48, v49
    v_cvt_pk_bf16_f32 v43, v50, v51
    v_pk_max_i16 v36, v36, 0
    v_pk_max_i16 v37, v37, 0
    v_pk_max_i16 v38, v38, 0
    v_pk_max_i16 v39, v39, 0
    v_pk_max_i16 v40, v40, 0
    v_pk_max_i16 v41, v41, 0
    v_pk_max_i16 v42, v42, 0
    v_pk_max_i16 v43, v43, 0
    ds_write_b128 v18, v[36:39] offset:13824
    ds_write_b128 v19, v[40:43] offset:13824
    ds_read_b128 v[52:55], v22 offset:13824
    ds_read_b128 v[56:59], v22 offset:14848
    v_mfma_f32_32x32x16_bf16 v[208:223], v[112:115], v[172:175], v[208:223]
    v_max_f32 v248, v192, v193
    v_max3_f32 v248, v248, v194, v195
    v_max3_f32 v248, v248, v196, v197
    v_max3_f32 v248, v248, v198, v199
    v_max3_f32 v248, v248, v200, v201
    v_max3_f32 v248, v248, v202, v203
    v_mfma_f32_32x32x16_bf16 v[224:239], v[116:119], v[168:171], 0
    v_max3_f32 v248, v248, v204, v205
    v_max3_f32 v248, v248, v206, v207
    s_nop 2
    v_max3_f32 v248, v248, v208, v209
    v_mfma_f32_32x32x16_bf16 v[224:239], v[120:123], v[172:175], v[224:239]
    v_max3_f32 v248, v248, v210, v211
    v_max3_f32 v248, v248, v212, v213
    v_max3_f32 v248, v248, v214, v215
    v_max3_f32 v248, v248, v216, v217
    v_max3_f32 v248, v248, v218, v219
    v_max3_f32 v248, v248, v220, v221
    v_mfma_f32_16x16x32_bf16 v[240:243], v[124:127], v[168:171], v[28:31]
    v_max3_f32 v248, v248, v222, v223
    s_waitcnt lgkmcnt(1)
    buffer_store_dwordx4 v[52:55], v23, s[24:27], 0 offen sc1 nt
    s_waitcnt lgkmcnt(0)
    buffer_store_dwordx4 v[56:59], v23, s[24:27], 0 offen offset:2048 sc1 nt
    v_mfma_f32_16x16x32_bf16 v[240:243], v[128:131], v[172:175], v[240:243]
    v_max3_f32 v248, v248, v224, v225
    v_mfma_f32_32x32x16_bf16 v[52:67], v[84:87], v[68:71], 0
    v_max3_f32 v248, v248, v226, v227
    v_max3_f32 v248, v248, v228, v229
    v_max3_f32 v248, v248, v230, v231
    v_max3_f32 v248, v248, v232, v233
    v_max3_f32 v248, v248, v234, v235
    v_max3_f32 v248, v248, v236, v237
    v_mfma_f32_32x32x16_bf16 v[52:67], v[88:91], v[72:75], v[52:67]
    v_max3_f32 v248, v248, v238, v239
    v_max3_f32 v248, v248, v240, v241
    v_max3_f32 v248, v248, v242, v243
    v_mov_b32 v249, v248
    v_mfma_f32_32x32x16_bf16 v[52:67], v[92:95], v[76:79], v[52:67]
    s_nop 0
    v_permlane32_swap_b32 v248, v249
    v_max_f32 v248, v248, v249
    v_sub_f32 v192, v192, v248
    v_exp_f32 v192, v192
    v_mfma_f32_32x32x16_bf16 v[52:67], v[96:99], v[80:83], v[52:67]
    v_sub_f32 v193, v193, v248
    v_exp_f32 v193, v193
    v_sub_f32 v194, v194, v248
    v_exp_f32 v194, v194
    v_sub_f32 v195, v195, v248
    v_exp_f32 v195, v195
    v_sub_f32 v196, v196, v248
    v_exp_f32 v196, v196
    v_sub_f32 v197, v197, v248
    v_exp_f32 v197, v197
    v_sub_f32 v198, v198, v248
    v_exp_f32 v198, v198
    v_sub_f32 v199, v199, v248
    v_exp_f32 v199, v199
    v_sub_f32 v200, v200, v248
    v_exp_f32 v200, v200
    v_sub_f32 v201, v201, v248
    v_exp_f32 v201, v201
    v_sub_f32 v202, v202, v248
    v_exp_f32 v202, v202
    v_sub_f32 v203, v203, v248
    v_exp_f32 v203, v203
    v_sub_f32 v204, v204, v248
    v_exp_f32 v204, v204
    v_sub_f32 v205, v205, v248
    v_exp_f32 v205, v205
    v_sub_f32 v206, v206, v248
    v_exp_f32 v206, v206
    v_sub_f32 v207, v207, v248
    v_exp_f32 v207, v207
    v_sub_f32 v208, v208, v248
    v_exp_f32 v208, v208
    v_sub_f32 v209, v209, v248
    v_exp_f32 v209, v209
    v_sub_f32 v210, v210, v248
    v_exp_f32 v210, v210
    v_sub_f32 v211, v211, v248
    v_exp_f32 v211, v211
    v_sub_f32 v212, v212, v248
    v_exp_f32 v212, v212
    v_sub_f32 v213, v213, v248
    v_exp_f32 v213, v213
    v_sub_f32 v214, v214, v248
    v_exp_f32 v214, v214
    v_sub_f32 v215, v215, v248
    v_exp_f32 v215, v215
    v_sub_f32 v216, v216, v248
    v_exp_f32 v216, v216
    v_sub_f32 v217, v217, v248
    v_exp_f32 v217, v217
    v_sub_f32 v218, v218, v248
    v_exp_f32 v218, v218
    v_sub_f32 v219, v219, v248
    v_exp_f32 v219, v219
    v_sub_f32 v220, v220, v248
    v_exp_f32 v220, v220
    v_sub_f32 v221, v221, v248
    v_exp_f32 v221, v221
    v_sub_f32 v222, v222, v248
    v_exp_f32 v222, v222
    v_sub_f32 v223, v223, v248
    v_exp_f32 v223, v223
    v_sub_f32 v224, v224, v248
    v_exp_f32 v224, v224
    v_sub_f32 v225, v225, v248
    v_exp_f32 v225, v225
    v_sub_f32 v226, v226, v248
    v_exp_f32 v226, v226
    v_sub_f32 v227, v227, v248
    v_exp_f32 v227, v227
    v_sub_f32 v228, v228, v248
    v_exp_f32 v228, v228
    v_sub_f32 v229, v229, v248
    v_exp_f32 v229, v229
    v_sub_f32 v230, v230, v248
    v_exp_f32 v230, v230
    v_sub_f32 v231, v231, v248
    v_exp_f32 v231, v231
    v_sub_f32 v232, v232, v248
    v_exp_f32 v232, v232
    v_sub_f32 v233, v233, v248
    v_exp_f32 v233, v233
    v_sub_f32 v234, v234, v248
    v_exp_f32 v234, v234
    v_sub_f32 v235, v235, v248
    v_exp_f32 v235, v235
    v_sub_f32 v236, v236, v248
    v_exp_f32 v236, v236
    v_sub_f32 v237, v237, v248
    v_exp_f32 v237, v237
    v_sub_f32 v238, v238, v248
    v_exp_f32 v238, v238
    v_sub_f32 v239, v239, v248
    v_exp_f32 v239, v239
    v_sub_f32 v240, v240, v248
    v_exp_f32 v240, v240
    v_sub_f32 v241, v241, v248
    v_exp_f32 v241, v241
    v_sub_f32 v242, v242, v248
    v_exp_f32 v242, v242
    v_sub_f32 v243, v243, v248
    v_exp_f32 v243, v243
    v_cvt_pk_bf16_f32 v192, v192, v193
    v_cvt_pk_bf16_f32 v193, v194, v195
    v_cvt_pk_bf16_f32 v194, v196, v197
    v_cvt_pk_bf16_f32 v195, v198, v199
    v_cvt_pk_bf16_f32 v200, v200, v201
    v_cvt_pk_bf16_f32 v201, v202, v203
    v_cvt_pk_bf16_f32 v202, v204, v205
    v_cvt_pk_bf16_f32 v203, v206, v207
    v_cvt_pk_bf16_f32 v208, v208, v209
    v_cvt_pk_bf16_f32 v209, v210, v211
    v_cvt_pk_bf16_f32 v210, v212, v213
    v_cvt_pk_bf16_f32 v211, v214, v215
    v_cvt_pk_bf16_f32 v216, v216, v217
    v_cvt_pk_bf16_f32 v217, v218, v219
    v_cvt_pk_bf16_f32 v218, v220, v221
    v_cvt_pk_bf16_f32 v219, v222, v223
    v_cvt_pk_bf16_f32 v224, v224, v225
    v_cvt_pk_bf16_f32 v225, v226, v227
    v_cvt_pk_bf16_f32 v226, v228, v229
    v_cvt_pk_bf16_f32 v227, v230, v231
    v_cvt_pk_bf16_f32 v232, v232, v233
    v_cvt_pk_bf16_f32 v233, v234, v235
    v_cvt_pk_bf16_f32 v234, v236, v237
    v_cvt_pk_bf16_f32 v235, v238, v239
    v_cvt_pk_bf16_f32 v32, v240, v241
    v_cvt_pk_bf16_f32 v33, v242, v243
    v_mfma_f32_32x32x16_bf16 v[36:51], v[132:135], v[192:195], 0
    ds_read_b128 v[68:71], v9 offset:8192
    ds_read_b128 v[72:75], v10 offset:8192
    ds_read_b128 v[76:79], v11 offset:8192
    v_mfma_f32_16x16x32_bf16 v[244:247], v[24:27], v[192:195], 0
    ds_read_b128 v[80:83], v12 offset:8192
    v_mfma_f32_32x32x16_bf16 v[36:51], v[136:139], v[200:203], v[36:51]
    v_mfma_f32_16x16x32_bf16 v[244:247], v[24:27], v[200:203], v[244:247]
    v_mfma_f32_32x32x16_bf16 v[36:51], v[140:143], v[208:211], v[36:51]
    v_mfma_f32_16x16x32_bf16 v[244:247], v[24:27], v[208:211], v[244:247]
    v_mfma_f32_32x32x16_bf16 v[36:51], v[144:147], v[216:219], v[36:51]
    v_mfma_f32_16x16x32_bf16 v[244:247], v[24:27], v[216:219], v[244:247]
    v_mfma_f32_32x32x16_bf16 v[36:51], v[148:151], v[224:227], v[36:51]
    v_mfma_f32_16x16x32_bf16 v[244:247], v[24:27], v[224:227], v[244:247]
    v_mfma_f32_32x32x16_bf16 v[36:51], v[152:155], v[232:235], v[36:51]
    v_mfma_f32_16x16x32_bf16 v[244:247], v[24:27], v[232:235], v[244:247]
    v_mfma_f32_32x32x16_bf16 v[36:51], v[156:159], v[32:35], v[36:51]
    v_mfma_f32_16x16x32_bf16 v[244:247], v[24:27], v[32:35], v[244:247]
    v_mfma_f32_32x32x16_bf16 v[192:207], v[100:103], v[176:179], 0
    v_mfma_f32_32x32x16_bf16 v[192:207], v[104:107], v[180:183], v[192:207]
    v_rcp_f32 v250, v244
    v_mfma_f32_32x32x16_bf16 v[208:223], v[108:111], v[176:179], 0
    v_fma_f32 v36, v36, v250, v52
    v_fma_f32 v37, v37, v250, v53
    v_fma_f32 v38, v38, v250, v54
    v_fma_f32 v39, v39, v250, v55
    v_fma_f32 v40, v40, v250, v56
    v_fma_f32 v41, v41, v250, v57
    v_fma_f32 v42, v42, v250, v58
    v_fma_f32 v43, v43, v250, v59
    v_fma_f32 v44, v44, v250, v60
    v_fma_f32 v45, v45, v250, v61
    v_fma_f32 v46, v46, v250, v62
    v_fma_f32 v47, v47, v250, v63
    v_fma_f32 v48, v48, v250, v64
    v_fma_f32 v49, v49, v250, v65
    v_fma_f32 v50, v50, v250, v66
    v_fma_f32 v51, v51, v250, v67
    v_cvt_pk_bf16_f32 v36, v36, v37
    v_cvt_pk_bf16_f32 v37, v38, v39
    v_cvt_pk_bf16_f32 v38, v40, v41
    v_cvt_pk_bf16_f32 v39, v42, v43
    v_cvt_pk_bf16_f32 v40, v44, v45
    v_cvt_pk_bf16_f32 v41, v46, v47
    v_cvt_pk_bf16_f32 v42, v48, v49
    v_cvt_pk_bf16_f32 v43, v50, v51
    v_pk_max_i16 v36, v36, 0
    v_pk_max_i16 v37, v37, 0
    v_pk_max_i16 v38, v38, 0
    v_pk_max_i16 v39, v39, 0
    v_pk_max_i16 v40, v40, 0
    v_pk_max_i16 v41, v41, 0
    v_pk_max_i16 v42, v42, 0
    v_pk_max_i16 v43, v43, 0
    ds_write_b128 v18, v[36:39] offset:13824
    ds_write_b128 v19, v[40:43] offset:13824
    ds_read_b128 v[52:55], v22 offset:13824
    ds_read_b128 v[56:59], v22 offset:14848
    v_mfma_f32_32x32x16_bf16 v[208:223], v[112:115], v[180:183], v[208:223]
    v_max_f32 v248, v192, v193
    v_max3_f32 v248, v248, v194, v195
    v_max3_f32 v248, v248, v196, v197
    v_max3_f32 v248, v248, v198, v199
    v_max3_f32 v248, v248, v200, v201
    v_max3_f32 v248, v248, v202, v203
    v_mfma_f32_32x32x16_bf16 v[224:239], v[116:119], v[176:179], 0
    v_max3_f32 v248, v248, v204, v205
    v_max3_f32 v248, v248, v206, v207
    s_nop 2
    v_max3_f32 v248, v248, v208, v209
    v_mfma_f32_32x32x16_bf16 v[224:239], v[120:123], v[180:183], v[224:239]
    v_max3_f32 v248, v248, v210, v211
    v_max3_f32 v248, v248, v212, v213
    v_max3_f32 v248, v248, v214, v215
    v_max3_f32 v248, v248, v216, v217
    v_max3_f32 v248, v248, v218, v219
    v_max3_f32 v248, v248, v220, v221
    v_mfma_f32_16x16x32_bf16 v[240:243], v[124:127], v[176:179], v[28:31]
    v_max3_f32 v248, v248, v222, v223
    s_waitcnt lgkmcnt(1)
    buffer_store_dwordx4 v[52:55], v23, s[24:27], s38 offen sc1 nt
    s_waitcnt lgkmcnt(0)
    buffer_store_dwordx4 v[56:59], v23, s[24:27], s38 offen offset:2048 sc1 nt
    v_mfma_f32_16x16x32_bf16 v[240:243], v[128:131], v[180:183], v[240:243]
    v_max3_f32 v248, v248, v224, v225
    v_mfma_f32_32x32x16_bf16 v[52:67], v[84:87], v[68:71], 0
    v_max3_f32 v248, v248, v226, v227
    v_max3_f32 v248, v248, v228, v229
    v_max3_f32 v248, v248, v230, v231
    v_max3_f32 v248, v248, v232, v233
    v_max3_f32 v248, v248, v234, v235
    v_max3_f32 v248, v248, v236, v237
    v_mfma_f32_32x32x16_bf16 v[52:67], v[88:91], v[72:75], v[52:67]
    v_max3_f32 v248, v248, v238, v239
    v_max3_f32 v248, v248, v240, v241
    v_max3_f32 v248, v248, v242, v243
    v_mov_b32 v249, v248
    v_mfma_f32_32x32x16_bf16 v[52:67], v[92:95], v[76:79], v[52:67]
    s_nop 0
    v_permlane32_swap_b32 v248, v249
    v_max_f32 v248, v248, v249
    v_sub_f32 v192, v192, v248
    v_exp_f32 v192, v192
    v_mfma_f32_32x32x16_bf16 v[52:67], v[96:99], v[80:83], v[52:67]
    v_sub_f32 v193, v193, v248
    v_exp_f32 v193, v193
    v_sub_f32 v194, v194, v248
    v_exp_f32 v194, v194
    v_sub_f32 v195, v195, v248
    v_exp_f32 v195, v195
    v_sub_f32 v196, v196, v248
    v_exp_f32 v196, v196
    v_sub_f32 v197, v197, v248
    v_exp_f32 v197, v197
    v_sub_f32 v198, v198, v248
    v_exp_f32 v198, v198
    v_sub_f32 v199, v199, v248
    v_exp_f32 v199, v199
    v_sub_f32 v200, v200, v248
    v_exp_f32 v200, v200
    v_sub_f32 v201, v201, v248
    v_exp_f32 v201, v201
    v_sub_f32 v202, v202, v248
    v_exp_f32 v202, v202
    v_sub_f32 v203, v203, v248
    v_exp_f32 v203, v203
    v_sub_f32 v204, v204, v248
    v_exp_f32 v204, v204
    v_sub_f32 v205, v205, v248
    v_exp_f32 v205, v205
    v_sub_f32 v206, v206, v248
    v_exp_f32 v206, v206
    v_sub_f32 v207, v207, v248
    v_exp_f32 v207, v207
    v_sub_f32 v208, v208, v248
    v_exp_f32 v208, v208
    v_sub_f32 v209, v209, v248
    v_exp_f32 v209, v209
    v_sub_f32 v210, v210, v248
    v_exp_f32 v210, v210
    v_sub_f32 v211, v211, v248
    v_exp_f32 v211, v211
    v_sub_f32 v212, v212, v248
    v_exp_f32 v212, v212
    v_sub_f32 v213, v213, v248
    v_exp_f32 v213, v213
    v_sub_f32 v214, v214, v248
    v_exp_f32 v214, v214
    v_sub_f32 v215, v215, v248
    v_exp_f32 v215, v215
    v_sub_f32 v216, v216, v248
    v_exp_f32 v216, v216
    v_sub_f32 v217, v217, v248
    v_exp_f32 v217, v217
    v_sub_f32 v218, v218, v248
    v_exp_f32 v218, v218
    v_sub_f32 v219, v219, v248
    v_exp_f32 v219, v219
    v_sub_f32 v220, v220, v248
    v_exp_f32 v220, v220
    v_sub_f32 v221, v221, v248
    v_exp_f32 v221, v221
    v_sub_f32 v222, v222, v248
    v_exp_f32 v222, v222
    v_sub_f32 v223, v223, v248
    v_exp_f32 v223, v223
    v_sub_f32 v224, v224, v248
    v_exp_f32 v224, v224
    v_sub_f32 v225, v225, v248
    v_exp_f32 v225, v225
    v_sub_f32 v226, v226, v248
    v_exp_f32 v226, v226
    v_sub_f32 v227, v227, v248
    v_exp_f32 v227, v227
    v_sub_f32 v228, v228, v248
    v_exp_f32 v228, v228
    v_sub_f32 v229, v229, v248
    v_exp_f32 v229, v229
    v_sub_f32 v230, v230, v248
    v_exp_f32 v230, v230
    v_sub_f32 v231, v231, v248
    v_exp_f32 v231, v231
    v_sub_f32 v232, v232, v248
    v_exp_f32 v232, v232
    v_sub_f32 v233, v233, v248
    v_exp_f32 v233, v233
    v_sub_f32 v234, v234, v248
    v_exp_f32 v234, v234
    v_sub_f32 v235, v235, v248
    v_exp_f32 v235, v235
    v_sub_f32 v236, v236, v248
    v_exp_f32 v236, v236
    v_sub_f32 v237, v237, v248
    v_exp_f32 v237, v237
    v_sub_f32 v238, v238, v248
    v_exp_f32 v238, v238
    v_sub_f32 v239, v239, v248
    v_exp_f32 v239, v239
    v_sub_f32 v240, v240, v248
    v_exp_f32 v240, v240
    v_sub_f32 v241, v241, v248
    v_exp_f32 v241, v241
    v_sub_f32 v242, v242, v248
    v_exp_f32 v242, v242
    v_sub_f32 v243, v243, v248
    v_exp_f32 v243, v243
    v_cvt_pk_bf16_f32 v192, v192, v193
    v_cvt_pk_bf16_f32 v193, v194, v195
    v_cvt_pk_bf16_f32 v194, v196, v197
    v_cvt_pk_bf16_f32 v195, v198, v199
    v_cvt_pk_bf16_f32 v200, v200, v201
    v_cvt_pk_bf16_f32 v201, v202, v203
    v_cvt_pk_bf16_f32 v202, v204, v205
    v_cvt_pk_bf16_f32 v203, v206, v207
    v_cvt_pk_bf16_f32 v208, v208, v209
    v_cvt_pk_bf16_f32 v209, v210, v211
    v_cvt_pk_bf16_f32 v210, v212, v213
    v_cvt_pk_bf16_f32 v211, v214, v215
    v_cvt_pk_bf16_f32 v216, v216, v217
    v_cvt_pk_bf16_f32 v217, v218, v219
    v_cvt_pk_bf16_f32 v218, v220, v221
    v_cvt_pk_bf16_f32 v219, v222, v223
    v_cvt_pk_bf16_f32 v224, v224, v225
    v_cvt_pk_bf16_f32 v225, v226, v227
    v_cvt_pk_bf16_f32 v226, v228, v229
    v_cvt_pk_bf16_f32 v227, v230, v231
    v_cvt_pk_bf16_f32 v232, v232, v233
    v_cvt_pk_bf16_f32 v233, v234, v235
    v_cvt_pk_bf16_f32 v234, v236, v237
    v_cvt_pk_bf16_f32 v235, v238, v239
    v_cvt_pk_bf16_f32 v32, v240, v241
    v_cvt_pk_bf16_f32 v33, v242, v243
    v_mfma_f32_32x32x16_bf16 v[36:51], v[132:135], v[192:195], 0
    ds_read_b128 v[68:71], v13
    ds_read_b128 v[72:75], v14
    ds_read_b128 v[76:79], v15
    v_mfma_f32_16x16x32_bf16 v[244:247], v[24:27], v[192:195], 0
    ds_read_b128 v[80:83], v16
    v_mfma_f32_32x32x16_bf16 v[36:51], v[136:139], v[200:203], v[36:51]
    v_mfma_f32_16x16x32_bf16 v[244:247], v[24:27], v[200:203], v[244:247]
    v_mfma_f32_32x32x16_bf16 v[36:51], v[140:143], v[208:211], v[36:51]
    v_mfma_f32_16x16x32_bf16 v[244:247], v[24:27], v[208:211], v[244:247]
    v_mfma_f32_32x32x16_bf16 v[36:51], v[144:147], v[216:219], v[36:51]
    v_mfma_f32_16x16x32_bf16 v[244:247], v[24:27], v[216:219], v[244:247]
    v_mfma_f32_32x32x16_bf16 v[36:51], v[148:151], v[224:227], v[36:51]
    v_mfma_f32_16x16x32_bf16 v[244:247], v[24:27], v[224:227], v[244:247]
    v_mfma_f32_32x32x16_bf16 v[36:51], v[152:155], v[232:235], v[36:51]
    v_mfma_f32_16x16x32_bf16 v[244:247], v[24:27], v[232:235], v[244:247]
    v_mfma_f32_32x32x16_bf16 v[36:51], v[156:159], v[32:35], v[36:51]
    v_mfma_f32_16x16x32_bf16 v[244:247], v[24:27], v[32:35], v[244:247]
    v_mfma_f32_32x32x16_bf16 v[192:207], v[100:103], v[184:187], 0
    v_mfma_f32_32x32x16_bf16 v[192:207], v[104:107], v[188:191], v[192:207]
    v_rcp_f32 v250, v244
    v_mfma_f32_32x32x16_bf16 v[208:223], v[108:111], v[184:187], 0
    v_fma_f32 v36, v36, v250, v52
    v_fma_f32 v37, v37, v250, v53
    v_fma_f32 v38, v38, v250, v54
    v_fma_f32 v39, v39, v250, v55
    v_fma_f32 v40, v40, v250, v56
    v_fma_f32 v41, v41, v250, v57
    v_fma_f32 v42, v42, v250, v58
    v_fma_f32 v43, v43, v250, v59
    v_fma_f32 v44, v44, v250, v60
    v_fma_f32 v45, v45, v250, v61
    v_fma_f32 v46, v46, v250, v62
    v_fma_f32 v47, v47, v250, v63
    v_fma_f32 v48, v48, v250, v64
    v_fma_f32 v49, v49, v250, v65
    v_fma_f32 v50, v50, v250, v66
    v_fma_f32 v51, v51, v250, v67
    v_cvt_pk_bf16_f32 v36, v36, v37
    v_cvt_pk_bf16_f32 v37, v38, v39
    v_cvt_pk_bf16_f32 v38, v40, v41
    v_cvt_pk_bf16_f32 v39, v42, v43
    v_cvt_pk_bf16_f32 v40, v44, v45
    v_cvt_pk_bf16_f32 v41, v46, v47
    v_cvt_pk_bf16_f32 v42, v48, v49
    v_cvt_pk_bf16_f32 v43, v50, v51
    v_pk_max_i16 v36, v36, 0
    v_pk_max_i16 v37, v37, 0
    v_pk_max_i16 v38, v38, 0
    v_pk_max_i16 v39, v39, 0
    v_pk_max_i16 v40, v40, 0
    v_pk_max_i16 v41, v41, 0
    v_pk_max_i16 v42, v42, 0
    v_pk_max_i16 v43, v43, 0
    ds_write_b128 v18, v[36:39] offset:13824
    ds_write_b128 v19, v[40:43] offset:13824
    ds_read_b128 v[52:55], v22 offset:13824
    ds_read_b128 v[56:59], v22 offset:14848
    v_mfma_f32_32x32x16_bf16 v[208:223], v[112:115], v[188:191], v[208:223]
    v_max_f32 v248, v192, v193
    v_max3_f32 v248, v248, v194, v195
    v_max3_f32 v248, v248, v196, v197
    v_max3_f32 v248, v248, v198, v199
    v_max3_f32 v248, v248, v200, v201
    v_max3_f32 v248, v248, v202, v203
    v_mfma_f32_32x32x16_bf16 v[224:239], v[116:119], v[184:187], 0
    v_max3_f32 v248, v248, v204, v205
    v_max3_f32 v248, v248, v206, v207
    s_nop 2
    v_max3_f32 v248, v248, v208, v209
    v_mfma_f32_32x32x16_bf16 v[224:239], v[120:123], v[188:191], v[224:239]
    v_max3_f32 v248, v248, v210, v211
    v_max3_f32 v248, v248, v212, v213
    v_max3_f32 v248, v248, v214, v215
    v_max3_f32 v248, v248, v216, v217
    v_max3_f32 v248, v248, v218, v219
    v_max3_f32 v248, v248, v220, v221
    v_mfma_f32_16x16x32_bf16 v[240:243], v[124:127], v[184:187], v[28:31]
    v_max3_f32 v248, v248, v222, v223
    s_waitcnt lgkmcnt(1)
    buffer_store_dwordx4 v[52:55], v23, s[24:27], s39 offen sc1 nt
    s_waitcnt lgkmcnt(0)
    buffer_store_dwordx4 v[56:59], v23, s[24:27], s39 offen offset:2048 sc1 nt
    v_mfma_f32_16x16x32_bf16 v[240:243], v[128:131], v[188:191], v[240:243]
    v_max3_f32 v248, v248, v224, v225
    v_mfma_f32_32x32x16_bf16 v[52:67], v[84:87], v[68:71], 0
    v_max3_f32 v248, v248, v226, v227
    v_max3_f32 v248, v248, v228, v229
    v_max3_f32 v248, v248, v230, v231
    v_max3_f32 v248, v248, v232, v233
    v_max3_f32 v248, v248, v234, v235
    v_max3_f32 v248, v248, v236, v237
    v_mfma_f32_32x32x16_bf16 v[52:67], v[88:91], v[72:75], v[52:67]
    v_max3_f32 v248, v248, v238, v239
    v_max3_f32 v248, v248, v240, v241
    v_max3_f32 v248, v248, v242, v243
    v_mov_b32 v249, v248
    v_mfma_f32_32x32x16_bf16 v[52:67], v[92:95], v[76:79], v[52:67]
    s_nop 0
    v_permlane32_swap_b32 v248, v249
    v_max_f32 v248, v248, v249
    v_sub_f32 v192, v192, v248
    v_exp_f32 v192, v192
    v_mfma_f32_32x32x16_bf16 v[52:67], v[96:99], v[80:83], v[52:67]
    v_sub_f32 v193, v193, v248
    v_exp_f32 v193, v193
    v_sub_f32 v194, v194, v248
    v_exp_f32 v194, v194
    v_sub_f32 v195, v195, v248
    v_exp_f32 v195, v195
    v_sub_f32 v196, v196, v248
    v_exp_f32 v196, v196
    v_sub_f32 v197, v197, v248
    v_exp_f32 v197, v197
    v_sub_f32 v198, v198, v248
    v_exp_f32 v198, v198
    v_sub_f32 v199, v199, v248
    v_exp_f32 v199, v199
    v_sub_f32 v200, v200, v248
    v_exp_f32 v200, v200
    v_sub_f32 v201, v201, v248
    v_exp_f32 v201, v201
    v_sub_f32 v202, v202, v248
    v_exp_f32 v202, v202
    v_sub_f32 v203, v203, v248
    v_exp_f32 v203, v203
    v_sub_f32 v204, v204, v248
    v_exp_f32 v204, v204
    v_sub_f32 v205, v205, v248
    v_exp_f32 v205, v205
    v_sub_f32 v206, v206, v248
    v_exp_f32 v206, v206
    v_sub_f32 v207, v207, v248
    v_exp_f32 v207, v207
    v_sub_f32 v208, v208, v248
    v_exp_f32 v208, v208
    v_sub_f32 v209, v209, v248
    v_exp_f32 v209, v209
    v_sub_f32 v210, v210, v248
    v_exp_f32 v210, v210
    v_sub_f32 v211, v211, v248
    v_exp_f32 v211, v211
    v_sub_f32 v212, v212, v248
    v_exp_f32 v212, v212
    v_sub_f32 v213, v213, v248
    v_exp_f32 v213, v213
    v_sub_f32 v214, v214, v248
    v_exp_f32 v214, v214
    v_sub_f32 v215, v215, v248
    v_exp_f32 v215, v215
    v_sub_f32 v216, v216, v248
    v_exp_f32 v216, v216
    v_sub_f32 v217, v217, v248
    v_exp_f32 v217, v217
    v_sub_f32 v218, v218, v248
    v_exp_f32 v218, v218
    v_sub_f32 v219, v219, v248
    v_exp_f32 v219, v219
    v_sub_f32 v220, v220, v248
    v_exp_f32 v220, v220
    v_sub_f32 v221, v221, v248
    v_exp_f32 v221, v221
    v_sub_f32 v222, v222, v248
    v_exp_f32 v222, v222
    v_sub_f32 v223, v223, v248
    v_exp_f32 v223, v223
    v_sub_f32 v224, v224, v248
    v_exp_f32 v224, v224
    v_sub_f32 v225, v225, v248
    v_exp_f32 v225, v225
    v_sub_f32 v226, v226, v248
    v_exp_f32 v226, v226
    v_sub_f32 v227, v227, v248
    v_exp_f32 v227, v227
    v_sub_f32 v228, v228, v248
    v_exp_f32 v228, v228
    v_sub_f32 v229, v229, v248
    v_exp_f32 v229, v229
    v_sub_f32 v230, v230, v248
    v_exp_f32 v230, v230
    v_sub_f32 v231, v231, v248
    v_exp_f32 v231, v231
    v_sub_f32 v232, v232, v248
    v_exp_f32 v232, v232
    v_sub_f32 v233, v233, v248
    v_exp_f32 v233, v233
    v_sub_f32 v234, v234, v248
    v_exp_f32 v234, v234
    v_sub_f32 v235, v235, v248
    v_exp_f32 v235, v235
    v_sub_f32 v236, v236, v248
    v_exp_f32 v236, v236
    v_sub_f32 v237, v237, v248
    v_exp_f32 v237, v237
    v_sub_f32 v238, v238, v248
    v_exp_f32 v238, v238
    v_sub_f32 v239, v239, v248
    v_exp_f32 v239, v239
    v_sub_f32 v240, v240, v248
    v_exp_f32 v240, v240
    v_sub_f32 v241, v241, v248
    v_exp_f32 v241, v241
    v_sub_f32 v242, v242, v248
    v_exp_f32 v242, v242
    v_sub_f32 v243, v243, v248
    v_exp_f32 v243, v243
    v_cvt_pk_bf16_f32 v192, v192, v193
    v_cvt_pk_bf16_f32 v193, v194, v195
    v_cvt_pk_bf16_f32 v194, v196, v197
    v_cvt_pk_bf16_f32 v195, v198, v199
    v_cvt_pk_bf16_f32 v200, v200, v201
    v_cvt_pk_bf16_f32 v201, v202, v203
    v_cvt_pk_bf16_f32 v202, v204, v205
    v_cvt_pk_bf16_f32 v203, v206, v207
    v_cvt_pk_bf16_f32 v208, v208, v209
    v_cvt_pk_bf16_f32 v209, v210, v211
    v_cvt_pk_bf16_f32 v210, v212, v213
    v_cvt_pk_bf16_f32 v211, v214, v215
    v_cvt_pk_bf16_f32 v216, v216, v217
    v_cvt_pk_bf16_f32 v217, v218, v219
    v_cvt_pk_bf16_f32 v218, v220, v221
    v_cvt_pk_bf16_f32 v219, v222, v223
    v_cvt_pk_bf16_f32 v224, v224, v225
    v_cvt_pk_bf16_f32 v225, v226, v227
    v_cvt_pk_bf16_f32 v226, v228, v229
    v_cvt_pk_bf16_f32 v227, v230, v231
    v_cvt_pk_bf16_f32 v232, v232, v233
    v_cvt_pk_bf16_f32 v233, v234, v235
    v_cvt_pk_bf16_f32 v234, v236, v237
    v_cvt_pk_bf16_f32 v235, v238, v239
    v_cvt_pk_bf16_f32 v32, v240, v241
    v_cvt_pk_bf16_f32 v33, v242, v243
    v_mfma_f32_32x32x16_bf16 v[36:51], v[132:135], v[192:195], 0
    v_mfma_f32_16x16x32_bf16 v[244:247], v[24:27], v[192:195], 0
    v_mfma_f32_32x32x16_bf16 v[36:51], v[136:139], v[200:203], v[36:51]
    v_mfma_f32_16x16x32_bf16 v[244:247], v[24:27], v[200:203], v[244:247]
    v_mfma_f32_32x32x16_bf16 v[36:51], v[140:143], v[208:211], v[36:51]
    v_mfma_f32_16x16x32_bf16 v[244:247], v[24:27], v[208:211], v[244:247]
    v_mfma_f32_32x32x16_bf16 v[36:51], v[144:147], v[216:219], v[36:51]
    v_mfma_f32_16x16x32_bf16 v[244:247], v[24:27], v[216:219], v[244:247]
    v_mfma_f32_32x32x16_bf16 v[36:51], v[148:151], v[224:227], v[36:51]
    v_mfma_f32_16x16x32_bf16 v[244:247], v[24:27], v[224:227], v[244:247]
    v_mfma_f32_32x32x16_bf16 v[36:51], v[152:155], v[232:235], v[36:51]
    v_mfma_f32_16x16x32_bf16 v[244:247], v[24:27], v[232:235], v[244:247]
    v_mfma_f32_32x32x16_bf16 v[36:51], v[156:159], v[32:35], v[36:51]
    v_mfma_f32_16x16x32_bf16 v[244:247], v[24:27], v[32:35], v[244:247]
    s_nop 7
    v_rcp_f32 v250, v244
    s_nop 0
    v_fma_f32 v36, v36, v250, v52
    v_fma_f32 v37, v37, v250, v53
    v_fma_f32 v38, v38, v250, v54
    v_fma_f32 v39, v39, v250, v55
    v_fma_f32 v40, v40, v250, v56
    v_fma_f32 v41, v41, v250, v57
    v_fma_f32 v42, v42, v250, v58
    v_fma_f32 v43, v43, v250, v59
    v_fma_f32 v44, v44, v250, v60
    v_fma_f32 v45, v45, v250, v61
    v_fma_f32 v46, v46, v250, v62
    v_fma_f32 v47, v47, v250, v63
    v_fma_f32 v48, v48, v250, v64
    v_fma_f32 v49, v49, v250, v65
    v_fma_f32 v50, v50, v250, v66
    v_fma_f32 v51, v51, v250, v67
    v_cvt_pk_bf16_f32 v36, v36, v37
    v_cvt_pk_bf16_f32 v37, v38, v39
    v_cvt_pk_bf16_f32 v38, v40, v41
    v_cvt_pk_bf16_f32 v39, v42, v43
    v_cvt_pk_bf16_f32 v40, v44, v45
    v_cvt_pk_bf16_f32 v41, v46, v47
    v_cvt_pk_bf16_f32 v42, v48, v49
    v_cvt_pk_bf16_f32 v43, v50, v51
    v_pk_max_i16 v36, v36, 0
    v_pk_max_i16 v37, v37, 0
    v_pk_max_i16 v38, v38, 0
    v_pk_max_i16 v39, v39, 0
    v_pk_max_i16 v40, v40, 0
    v_pk_max_i16 v41, v41, 0
    v_pk_max_i16 v42, v42, 0
    v_pk_max_i16 v43, v43, 0
    ds_write_b128 v18, v[36:39] offset:13824
    ds_write_b128 v19, v[40:43] offset:13824
    ds_read_b128 v[52:55], v22 offset:13824
    ds_read_b128 v[56:59], v22 offset:14848
    s_waitcnt lgkmcnt(1)
    buffer_store_dwordx4 v[52:55], v23, s[24:27], s40 offen sc1 nt
    s_waitcnt lgkmcnt(0)
    buffer_store_dwordx4 v[56:59], v23, s[24:27], s40 offen offset:2048 sc1 nt
    s_waitcnt vmcnt(0) lgkmcnt(0)
    s_nop 15
    v_add_u32 v17, 0x1000, v17
    v_add_u32 v23, 64, v23
    s_add_u32 s30, s30, 1
    s_cmp_lt_u32 s30, 2
    s_cbranch_scc1 L_slow_head
L_end:
    s_endpgm
.section .rodata,"a"
.p2align 6
.amdhsa_kernel standalone__attention_interact_autoint__recsys_kernel
  .amdhsa_next_free_vgpr 512
  .amdhsa_next_free_sgpr 102
  .amdhsa_accum_offset 256
  .amdhsa_group_segment_fixed_size 0
  .amdhsa_dx10_clamp 0
  .amdhsa_kernarg_size 64
  .amdhsa_user_sgpr_count 2
  .amdhsa_user_sgpr_kernarg_segment_ptr 1
  .amdhsa_system_sgpr_workgroup_id_x 1
.end_amdhsa_kernel
```
